```python
import torch

def _softmax(x, axis=-1):
    return torch.softmax(x, dim=axis)
def _gelu(x):
    return torch.nn.functional.gelu(x, approximate="tanh")
def _silu(x):
    return torch.nn.functional.silu(x)
def _sigmoid(x):
    return torch.sigmoid(x)
def _layernorm(x, axis=-1, eps=1e-5):
    m = x.mean(dim=axis, keepdim=True)
    v = x.var(dim=axis, keepdim=True, unbiased=False)
    return (x - m) / torch.sqrt(v + eps)
def _scatter_add(tgt, idx, src, axis=0):
    return tgt.clone().index_add_(axis, idx, src)
def _segment_sum(src, seg, n):
    out = torch.zeros((n,) + src.shape[1:], dtype=src.dtype)
    return out.index_add_(0, seg, src)
def _pad(x, pw):
    flat = tuple(v for pair in reversed(pw) for v in pair)
    return torch.nn.functional.pad(x, flat)

kernel_name = 'concat_heads__ssm_conv_s4d__ssm_conv_s4__prompt'

def setup_inputs():

    _w = (lambda a: (lambda t: t.to(torch.bfloat16) if t.is_floating_point() else t)(torch.as_tensor(a)))
    def _A_setup():
        Bsz, L, D, N = 1, 2048, 512, 128
        return {
            "u": _w((lambda *s: torch.randn(*s, dtype=torch.bfloat16) * 0.05)(Bsz, L, D)),
            "log_A_real": _w((lambda *s: torch.randn(*s, dtype=torch.bfloat16) * 6.4)(D, N) * 0.5),
            "A_imag": _w((lambda *s: torch.randn(*s, dtype=torch.bfloat16) * 0.05)(D, N) * 3.14),
            "C_real": _w((lambda *s: torch.randn(*s, dtype=torch.bfloat16) * 0.05)(D, N) / N ** 0.5),
            "C_imag": _w((lambda *s: torch.randn(*s, dtype=torch.bfloat16) * 0.05)(D, N) / N ** 0.5),
            "log_dt": _w((lambda *s: torch.randn(*s, dtype=torch.bfloat16) * 0.05)(D) * 0.5 - 4.0),
            "D_skip": _w((lambda *s: torch.randn(*s, dtype=torch.bfloat16) * 0.05)(D)),
        }
    _A_in = _A_setup()

    def _B_setup():
        B, L, D, N = 1, 2048, 512, 128
        A_re = -(lambda _x: torch.exp(torch.as_tensor(_x)))((lambda *s: torch.randn(*s, dtype=torch.bfloat16) * 6.4)(D, N))
        A_im = torch.pi * (lambda *s: torch.randn(*s, dtype=torch.bfloat16) * 0.05)(D, N)
        B_re = (lambda *s: torch.randn(*s, dtype=torch.bfloat16) * 0.1)(D, N)
        B_im = (lambda *s: torch.randn(*s, dtype=torch.bfloat16) * 0.1)(D, N)
        C_re = (lambda *s: torch.randn(*s, dtype=torch.bfloat16) * 0.1)(D, N)
        C_im = (lambda *s: torch.randn(*s, dtype=torch.bfloat16) * 0.1)(D, N)
        log_dt = (lambda *s: torch.randn(*s, dtype=torch.bfloat16) * 0.05)(D) * 0.5 - 4.0
        Dskip = (lambda *s: torch.randn(*s, dtype=torch.bfloat16) * 0.05)(D)
        return {
            "u": _w((lambda *s: torch.randn(*s, dtype=torch.bfloat16) * 0.05)(B, L, D)),
            "A_re": _w(A_re),
            "A_im": _w(A_im),
            "B_re": _w(B_re),
            "B_im": _w(B_im),
            "C_re": _w(C_re),
            "C_im": _w(C_im),
            "log_dt": _w(log_dt),
            "Dskip": _w(Dskip),
        }
    _B_in = _B_setup()

    return {
        "A_u": _A_in["u"],
        "A_log_A_real": _A_in["log_A_real"],
        "A_A_imag": _A_in["A_imag"],
        "A_C_real": _A_in["C_real"],
        "A_C_imag": _A_in["C_imag"],
        "A_log_dt": _A_in["log_dt"],
        "A_D_skip": _A_in["D_skip"],
        "B_u": _B_in["u"],
        "B_A_re": _B_in["A_re"],
        "B_A_im": _B_in["A_im"],
        "B_B_re": _B_in["B_re"],
        "B_B_im": _B_in["B_im"],
        "B_C_re": _B_in["C_re"],
        "B_C_im": _B_in["C_im"],
        "B_log_dt": _B_in["log_dt"],
        "B_Dskip": _B_in["Dskip"],
    }

def reference(A_u, A_log_A_real, A_A_imag, A_C_real, A_C_imag, A_log_dt, A_D_skip, B_u, B_A_re, B_A_im, B_B_re, B_B_im, B_C_re, B_C_im, B_log_dt, B_Dskip):
    def _A_ref(u, log_A_real, A_imag, C_real, C_imag, log_dt, D_skip):
        L = u.shape[1]
        dt = torch.exp(log_dt)
        A = -torch.exp(log_A_real) + 1j * A_imag
        C = (C_real + 1j * C_imag) * dt[:, None]
        pos = (lambda x, dt: x.to(dt))(torch.arange(L), log_dt.dtype)
        P = torch.exp((A * dt[:, None])[:, :, None] * pos[None, None, :])
        K = 2.0 * torch.einsum("dn,dnl->dl", C, P).real
        L2 = 2 * L
        u_t = (lambda x, *d: x.permute(*d))(u, 0, 2, 1)
        Kf = (lambda x, *a, **k: torch.fft.rfft(x.float(), *a, **k))(K, L2)
        Uf = (lambda x, *a, **k: torch.fft.rfft(x.float(), *a, **k))(u_t, L2)
        y = (lambda x, *a, **k: torch.fft.irfft(x, *a, **k).to(torch.bfloat16))(Uf * Kf[None, :, :], L2)[:, :, :L]
        y = (lambda x, *d: x.permute(*d))(y, 0, 2, 1)
        return y + u * D_skip[None, None, :]

    def _B_ref(u, A_re, A_im, B_re, B_im, C_re, C_im, log_dt, Dskip):
        Bsz, L, D = u.shape
        dt = torch.exp(log_dt)[:, None]
        A = A_re + 1j * A_im
        Bc = B_re + 1j * B_im
        Cc = C_re + 1j * C_im
        logdA = dt * A
        dB = dt * Bc
        l = (lambda x, dt: x.to(dt))(torch.arange(L), A_re.dtype)
        P = torch.exp(logdA[:, :, None] * l[None, None, :])
        K = torch.einsum("dn,dnl,dn->dl", Cc, P, dB).real
        L2 = 2 * L
        Kp = _pad(K, ((0, 0), (0, L)))
        up = (lambda x, *d: x.permute(*d))(u, 0, 2, 1)
        up = _pad(up, ((0, 0), (0, 0), (0, L)))
        Kf = (lambda x, axes=(-2,-1): torch.fft.rfft2(x.float(), dim=axes))(Kp[:, None, :], axes=(-2, -1))
        Uf = (lambda x, axes=(-2,-1): torch.fft.rfft2(x.float(), dim=axes))(up[:, :, None, :], axes=(-2, -1))
        Yf = Uf * Kf[None, :, :, :]
        y = (lambda x, s, axes=(-2,-1): torch.fft.irfft2(x, s=s, dim=axes).to(torch.bfloat16))(Yf, (1, L2), axes=(-2, -1))[:, :, 0, :L]
        y = (lambda x, *d: x.permute(*d))(y, 0, 2, 1) + u * Dskip[None, None, :]
        return y

    a = _A_ref(A_u, A_log_A_real, A_A_imag, A_C_real, A_C_imag, A_log_dt, A_D_skip)
    b = _B_ref(B_u, B_A_re, B_A_im, B_B_re, B_B_im, B_C_re, B_C_im, B_log_dt, B_Dskip)
    return torch.concatenate([a, b], axis=-1)
```

```asm
; @launch grid=(256,1,1) block=(512,1,1) lds=157952
.amdgcn_target "amdgcn-amd-amdhsa--gfx950"
.text
.globl concat_heads__ssm_conv_s4d__ssm_conv_s4__prompt_kernel
.p2align 12
.fill 832, 4, 0xbf800000
.p2align 8
.type concat_heads__ssm_conv_s4d__ssm_conv_s4__prompt_kernel,@function
concat_heads__ssm_conv_s4d__ssm_conv_s4__prompt_kernel:
    s_cmp_ge_u32 s2, 0x100
    s_cbranch_scc1 Lend
    s_bfe_u32 s6, s2, 0x10002
    s_mul_i32 s5, s6, 56
    s_load_dwordx16 s[8:23], s[0:1], s5
    s_load_dwordx4 s[24:27], s[0:1], 120
    s_load_dwordx2 s[48:49], s[0:1], 144
    v_lshrrev_b32 v1, 6, v0
    v_and_b32 v2, 63, v0
    s_getpc_b64 s[38:39]
    s_and_b32 s5, s2, 0xf8
    v_add_lshl_u32 v54, v1, s5, 7
    v_min_u32 v54, Lend-concat_heads__ssm_conv_s4d__ssm_conv_s4__prompt_kernel-128, v54
    global_load_dword v59, v54, s[38:39]
    v_readfirstlane_b32 s4, v1
    s_and_b32 s3, s2, 7
    s_lshl_b32 s3, s3, 4
    s_lshr_b32 s5, s2, 4
    s_or_b32 s3, s3, s5
    s_and_b32 s7, s3, 63
    s_bfe_u32 s43, s2, 0x10003
    s_xor_b32 s4, s4, 4
    s_and_b32 s31, s4, 3
    s_lshr_b32 s45, s4, 2
    s_lshl_b32 s5, s43, 2
    s_xor_b32 s5, s5, 4
    s_or_b32 s32, s5, s31
    s_xor_b32 s33, s5, s4
    s_lshl3_add_u32 s5, s7, s32
    s_lshl_b32 s28, s5, 1
    v_mov_b32 v53, s28
    s_add_u32 s28, s28, s45
    s_lshl_b32 s28, s28, 7
    v_lshl_add_u32 v52, v2, 1, s28
    v_mov_b64 v[66:67], 0
    v_mov_b64 v[68:69], 0
    v_mov_b64 v[70:71], 0
    v_mov_b64 v[72:73], 0
    v_mov_b32 v63, 0
    v_mov_b32 v72, 2.0
    s_lshl3_add_u32 s5, s3, s33
    s_lshl_b32 s44, s5, 11
    v_lshl_add_u32 v14, v2, 4, s44
    s_lshl_b32 s44, s3, 7
    s_add_u32 s44, s44, 0x200000
    v_and_b32 v3, 0xfffffdff, v14
    v_and_b32 v54, 0xff, v0
    s_lshl_b32 s5, s3, 4
    v_lshl_add_u32 v13, v54, 11, s5
    s_mul_i32 s28, s31, 29760
    s_add_u32 s28, s28, 38912
    s_mul_i32 s29, s45, 8320
    s_add_u32 s29, s29, s28
    s_add_u32 s29, s29, 12704
    s_mul_i32 s30, s33, 4608
    v_and_b32 v57, 15, v2
    v_lshrrev_b32 v58, 4, v2
    v_and_b32 v15, 0x1fbff, v13
    s_and_b32 s42, s3, 1
    v_lshl_or_b32 v15, s42, 10, v15
    v_xor_b32 v1, 0x400, v15
    s_lshr_b32 s5, s3, 1
    s_add_u32 s5, s5, s31
    s_and_b32 s5, s5, 3
    s_and_b32 s99, s32, 4
    s_or_b32 s99, s99, s5
    s_cmp_ge_u32 s4, 4
    s_cbranch_scc0 Lnobox
    s_add_u32 s5, s31, 33
    v_subrev_u32 v54, s5, v2
    v_cvt_f32_i32 v54, v54
    s_add_u32 s5, s31, 2
    v_cvt_f32_u32 v55, s5
    v_sub_f32_e64 v74, v55, abs(v54) clamp
    v_add_f32 v54, -1.0, v54
    v_sub_f32_e64 v75, v55, abs(v54) clamp
    v_add_f32 v54, -1.0, v54
    v_sub_f32_e64 v76, v55, abs(v54) clamp
    v_add_f32 v54, -1.0, v54
    v_sub_f32_e64 v77, v55, abs(v54) clamp
    v_cvt_pk_bf16_f32 v74, v74, v75
    v_cvt_pk_bf16_f32 v75, v76, v77
    v_lshlrev_b32 v54, 3, v0
    ds_write_b64 v54, v[74:75] offset:36864
Lnobox:
    s_cmp_eq_u32 s6, 0
    s_waitcnt lgkmcnt(0)
    s_cbranch_scc0 LldB
    global_load_short_d16_hi v66, v53, s[18:19]
    global_load_short_d16_hi v67, v52, s[10:11]
    global_load_short_d16_hi v69, v52, s[12:13]
    s_barrier
    global_load_short_d16_hi v63, v53, s[20:21]
    s_branch LldJ
LldB:
    global_load_short_d16_hi v66, v53, s[22:23]
    global_load_short_d16_hi v68, v52, s[10:11]
    global_load_short_d16_hi v69, v52, s[12:13]
    s_barrier
    global_load_short_d16_hi v72, v52, s[18:19]
    global_load_short_d16_hi v73, v52, s[20:21]
    global_load_short_d16_hi v63, v53, s[24:25]
LldJ:
    global_load_short_d16_hi v70, v52, s[14:15]
    global_load_short_d16_hi v71, v52, s[16:17]
    s_barrier
    s_cmp_ge_u32 s4, 4
    s_cbranch_scc0 Lnou
    s_xor_b32 s5, s99, 0
    s_lshl_b32 s5, s5, 17
    s_add_u32 s38, s8, s5
    s_addc_u32 s39, s9, 0
    global_load_dwordx4 v[120:123], v15, s[38:39]
    global_load_dwordx4 v[124:127], v1, s[38:39]
    s_and_b32 s5, s99, 6
    s_cmp_eq_u32 s5, 2
    s_cselect_b64 exec, 1, -1
    s_xor_b32 s5, s99, 4
    s_lshl_b32 s5, s5, 17
    s_add_u32 s38, s8, s5
    s_addc_u32 s39, s9, 0
    global_load_dwordx4 v[128:131], v15, s[38:39]
    global_load_dwordx4 v[132:135], v1, s[38:39]
    s_mov_b64 exec, -1
Lnou:
    s_load_dword s50, s[48:49], s44
    v_mov_b64 v[74:75], 0
    s_lshl_b32 s5, s45, 8
    s_add_u32 m0, s5, s28
    v_lshl_add_u32 v54, v2, 3, s30
    v_mov_b32 v55, 0x3f80
    v_mad_i32_i24 v56, v58, -8, v57
    v_add_lshl_u32 v56, v56, 24, 3
    ds_write_b64 v54, v[74:75]
    ds_write_addtid_b32 v55 offset:12672
    ds_write_addtid_b32 v74 offset:6864
    ds_read_b64 v[20:21], v56 offset:37032
    ds_read_b64 v[22:23], v56 offset:37000
    ds_read_b64 v[24:25], v56 offset:37520
    ds_read_b64 v[26:27], v56 offset:37488
    ds_read_b64 v[28:29], v56 offset:36968
    ds_read_b64 v[30:31], v56 offset:36936
    ds_read_b64 v[32:33], v56 offset:37520
    ds_read_b64 v[34:35], v56 offset:37488
    ds_read_b64 v[36:37], v56 offset:38040
    ds_read_b64 v[38:39], v56 offset:38008
    ds_read_b64 v[40:41], v56 offset:38560
    ds_read_b64 v[42:43], v56 offset:38528
    s_mov_b32 s34, 0x3fb8aa3b
    s_mov_b32 s35, 0x3e22f983
    s_mov_b32 s52, 0x41000000
    s_movk_i32 s46, 272
    s_sub_u32 s36, s29, 16
    s_movk_i32 s47, 29760
    s_add_u32 s96, s29, 3588
    s_add_u32 s97, s29, 16
    s_mov_b32 s98, 55968
    s_mov_b32 s51, 0
    s_movk_i32 s101, 376
    v_and_b32 v56, 3, v2
    v_lshrrev_b32 v55, 2, v2
    v_lshl_add_u32 v54, v56, 3, s36
    v_mad_u32_u24 v62, v55, s46, v54
    v_lshl_add_u32 v54, v57, 3, s29
    v_mad_u32_u24 v64, v58, s101, v54
    v_lshrrev_b32 v65, 2, v57
    v_bfe_u32 v55, v0, 4, 4
    v_mad_u32_u24 v54, v56, 18, v55
    v_lshl_add_u32 v54, v54, 3, s98
    v_mad_u32_u24 v12, v65, s47, v54
    v_and_b32 v54, 7, v2
    v_lshrrev_b32 v55, 3, v57
    v_sub_u32 v55, v55, v58
    v_lshl_add_u32 v55, v55, 2, s97
    v_mad_u32_u24 v4, v54, s46, v55
    v_xor_b32 v54, 4, v54
    v_add_u32 v55, 28, v57
    v_lshrrev_b32 v55, 3, v55
    v_sub_u32 v55, v55, v58
    v_lshl_add_u32 v55, v55, 2, s29
    v_mad_u32_u24 v5, v54, s46, v55
    v_and_b32 v56, 1, v2
    v_lshrrev_b32 v55, 1, v57
    v_lshl_add_u32 v54, v56, 1, s29
    v_mad_u32_u24 v9, v55, s46, v54
    v_lshl_add_u32 v7, v2, 1, s29
    v_mad_i32_i24 v54, v58, -4, v57
    v_add_u32 v54, 12, v54
    v_lshl_add_u32 v55, v54, 3, s29
    v_mad_u32_u24 v6, v56, s101, v55
    v_lshl_add_u32 v8, v54, 2, s96
    v_lshl_add_u32 v54, v57, 1, v58
    v_lshl_add_u32 v10, v54, 4, s30
    v_mad_u32_u24 v54, v58, 18, v57
    v_lshl_add_u32 v11, v54, 3, s29
    s_cmp_eq_u32 s42, 0
    s_mov_b32 s40, 0x01000504
    s_mov_b32 s41, 0x03020706
    s_cmov_b32 s40, 0x05040100
    s_cmov_b32 s41, 0x07060302
    s_cmp_ge_u32 s4, 4
    s_cbranch_scc0 LcX
    s_lshr_b32 s37, s7, 3
    s_cmp_eq_u32 s37, 2
    s_cselect_b32 s98, 14, 13
    s_cselect_b32 s96, -1, 0xffff
    s_cselect_b32 s47, -1, 0
    s_cmp_eq_u32 s37, 3
    s_cselect_b32 s96, 1, s96
    s_cselect_b32 s46, 1, -1
    s_mov_b32 s97, 0
    s_lshr_b32 s5, s2, 4
    s_lshl_b32 s5, s5, s98
    s_lshl_b32 s53, s31, 17
    s_add_u32 s5, s5, s53
    s_add_u32 s98, s5, 0x80000
    s_and_b32 s53, s7, 0x30
    s_lshl4_add_u32 s5, s53, s5
    s_add_u32 s5, s5, 0x100000
    v_lshrrev_b32 v65, 1, v2
    v_lshl_add_u32 v65, v65, 10, s5
    v_and_b32 v54, 1, v2
    v_lshl_add_u32 v65, v54, 7, v65
    s_cmp_eq_u32 s6, 0
    s_cbranch_scc0 LzYB
    s_waitcnt vmcnt(7)
    s_branch LsetA
LzYB:
    s_waitcnt vmcnt(9)
    s_branch LsetB
LcX:
    s_setprio 1
    v_and_b32 v54, 31, v2
    v_lshrrev_b32 v55, 5, v2
    v_lshl_add_u32 v55, v55, 4, s28
    s_movk_i32 s5, 528
    v_cmp_gt_u32 vcc, 24, v54
    v_mad_u32_u24 v61, v54, s5, v55
    s_nop 0
    v_cndmask_b32 v54, 13, v54, vcc
    v_writelane_b32 v54, 4, 5
    v_writelane_b32 v54, 4, 37
    v_writelane_b32 v54, 12, 7
    v_writelane_b32 v54, 12, 39
    v_writelane_b32 v54, 12, 13
    v_writelane_b32 v54, 12, 45
    v_mad_u32_u24 v60, v54, s5, v55
LcJ:
    s_cmp_eq_u32 s6, 0
    s_cbranch_scc0 LsetB0
    s_waitcnt vmcnt(3)
LsetA:
    v_pk_mul_f32 v[66:67], v[66:67], s[34:35] op_sel_hi:[1,0]
    v_exp_f32 v66, v66
    v_exp_f32 v67, v67
    s_nop 0
    v_cvt_pk_bf16_f32 v54, v66, -v67
    v_and_b32 v68, 0xffff0000, v54
    s_branch LsetJ
LsetB0:
    s_waitcnt vmcnt(5)
LsetB:
    v_mul_f32 v66, s34, v66
    v_exp_f32 v66, v66
    s_nop 0
    v_cvt_pk_bf16_f32 v54, v66, v66
LsetJ:
    v_lshlrev_b32 v80, 16, v54
    v_pk_mul_f32 v[78:79], v[80:81], s[34:35] op_sel_hi:[0,1]
    v_pk_mul_f32 v[82:83], v[68:69], v[78:79]
    v_pk_mul_f32 v[84:85], v[82:83], s[52:53] op_sel_hi:[1,0]
    v_fract_f32 v83, v83
    v_fract_f32 v85, v85
    v_exp_f32 v84, v84
    v_cos_f32 v88, v85
    v_sin_f32 v89, v85
    v_exp_f32 v82, v82
    v_cos_f32 v86, v83
    v_sin_f32 v87, v83
    v_pk_mul_f32 v[88:89], v[88:89], v[84:85] op_sel_hi:[1,0] neg_hi:[1,0]
    v_pk_mul_f32 v[86:87], v[86:87], v[82:83] op_sel_hi:[1,0]
    .p2align 3
    v_cvt_pk_bf16_f32 v114, v88, v89
    ds_write_addtid_b32 v114 offset:13200
    v_pk_mul_f32 v[90:91], v[88:89], v[88:89] op_sel_hi:[1,0]
    v_pk_fma_f32 v[92:93], v[88:89], v[88:89], v[90:91] op_sel:[1,1,0] op_sel_hi:[0,1,1] neg_lo:[1,0,0]
    v_cvt_pk_bf16_f32 v115, v92, v93
    ds_write_addtid_b32 v115 offset:13728
    v_pk_mul_f32 v[90:91], v[92:93], v[88:89] op_sel_hi:[1,0]
    v_pk_fma_f32 v[94:95], v[92:93], v[88:89], v[90:91] op_sel:[1,1,0] op_sel_hi:[0,1,1] neg_lo:[1,0,0]
    v_cvt_pk_bf16_f32 v116, v94, v95
    ds_write_addtid_b32 v116 offset:14256
    v_pk_mul_f32 v[90:91], v[94:95], v[88:89] op_sel_hi:[1,0]
    v_pk_fma_f32 v[92:93], v[94:95], v[88:89], v[90:91] op_sel:[1,1,0] op_sel_hi:[0,1,1] neg_lo:[1,0,0]
    v_cvt_pk_bf16_f32 v117, v92, v93
    ds_write_addtid_b32 v117 offset:14784
    v_pk_mul_f32 v[90:91], v[92:93], v[88:89] op_sel_hi:[1,0]
    v_pk_fma_f32 v[94:95], v[92:93], v[88:89], v[90:91] op_sel:[1,1,0] op_sel_hi:[0,1,1] neg_lo:[1,0,0]
    v_cvt_pk_bf16_f32 v114, v94, v95
    ds_write_addtid_b32 v114 offset:15312
    v_pk_mul_f32 v[90:91], v[94:95], v[88:89] op_sel_hi:[1,0]
    v_pk_fma_f32 v[92:93], v[94:95], v[88:89], v[90:91] op_sel:[1,1,0] op_sel_hi:[0,1,1] neg_lo:[1,0,0]
    v_cvt_pk_bf16_f32 v115, v92, v93
    ds_write_addtid_b32 v115 offset:15840
    v_pk_mul_f32 v[90:91], v[92:93], v[88:89] op_sel_hi:[1,0]
    v_pk_fma_f32 v[94:95], v[92:93], v[88:89], v[90:91] op_sel:[1,1,0] op_sel_hi:[0,1,1] neg_lo:[1,0,0]
    v_cvt_pk_bf16_f32 v116, v94, v95
    ds_write_addtid_b32 v116 offset:16368
    v_pk_mul_f32 v[90:91], v[94:95], v[88:89] op_sel_hi:[1,0]
    v_pk_fma_f32 v[92:93], v[94:95], v[88:89], v[90:91] op_sel:[1,1,0] op_sel_hi:[0,1,1] neg_lo:[1,0,0]
    v_cvt_pk_bf16_f32 v117, v92, v93
    ds_write_addtid_b32 v117 offset:16896
    v_pk_mul_f32 v[90:91], v[92:93], v[88:89] op_sel_hi:[1,0]
    v_pk_fma_f32 v[94:95], v[92:93], v[88:89], v[90:91] op_sel:[1,1,0] op_sel_hi:[0,1,1] neg_lo:[1,0,0]
    v_cvt_pk_bf16_f32 v114, v94, v95
    ds_write_addtid_b32 v114 offset:17424
    v_pk_mul_f32 v[90:91], v[94:95], v[88:89] op_sel_hi:[1,0]
    v_pk_fma_f32 v[92:93], v[94:95], v[88:89], v[90:91] op_sel:[1,1,0] op_sel_hi:[0,1,1] neg_lo:[1,0,0]
    v_cvt_pk_bf16_f32 v115, v92, v93
    ds_write_addtid_b32 v115 offset:17952
    v_pk_mul_f32 v[90:91], v[92:93], v[88:89] op_sel_hi:[1,0]
    v_pk_fma_f32 v[94:95], v[92:93], v[88:89], v[90:91] op_sel:[1,1,0] op_sel_hi:[0,1,1] neg_lo:[1,0,0]
    v_cvt_pk_bf16_f32 v116, v94, v95
    ds_write_addtid_b32 v116 offset:18480
    v_pk_mul_f32 v[90:91], v[94:95], v[88:89] op_sel_hi:[1,0]
    v_pk_fma_f32 v[92:93], v[94:95], v[88:89], v[90:91] op_sel:[1,1,0] op_sel_hi:[0,1,1] neg_lo:[1,0,0]
    v_cvt_pk_bf16_f32 v117, v92, v93
    ds_write_addtid_b32 v117 offset:19008
    v_pk_mul_f32 v[90:91], v[92:93], v[88:89] op_sel_hi:[1,0]
    v_pk_fma_f32 v[94:95], v[92:93], v[88:89], v[90:91] op_sel:[1,1,0] op_sel_hi:[0,1,1] neg_lo:[1,0,0]
    v_cvt_pk_bf16_f32 v114, v94, v95
    ds_write_addtid_b32 v114 offset:19536
    v_pk_mul_f32 v[90:91], v[94:95], v[88:89] op_sel_hi:[1,0]
    v_pk_fma_f32 v[92:93], v[94:95], v[88:89], v[90:91] op_sel:[1,1,0] op_sel_hi:[0,1,1] neg_lo:[1,0,0]
    v_cvt_pk_bf16_f32 v115, v92, v93
    ds_write_addtid_b32 v115 offset:20064
    v_pk_mul_f32 v[90:91], v[92:93], v[88:89] op_sel_hi:[1,0]
    v_pk_fma_f32 v[94:95], v[92:93], v[88:89], v[90:91] op_sel:[1,1,0] op_sel_hi:[0,1,1] neg_lo:[1,0,0]
    v_cvt_pk_bf16_f32 v116, v94, v95
    ds_write_addtid_b32 v116 offset:20592
    v_pk_mul_f32 v[90:91], v[94:95], v[88:89] op_sel_hi:[1,0]
    v_pk_fma_f32 v[92:93], v[94:95], v[88:89], v[90:91] op_sel:[1,1,0] op_sel_hi:[0,1,1] neg_lo:[1,0,0]
    v_cvt_pk_bf16_f32 v117, v92, v93
    ds_write_addtid_b32 v117 offset:21120
    v_pk_mul_f32 v[90:91], v[92:93], v[88:89] op_sel_hi:[1,0]
    v_pk_fma_f32 v[94:95], v[92:93], v[88:89], v[90:91] op_sel:[1,1,0] op_sel_hi:[0,1,1] neg_lo:[1,0,0]
    v_cvt_pk_bf16_f32 v114, v94, v95
    ds_write_addtid_b32 v114 offset:21648
    v_pk_mul_f32 v[90:91], v[94:95], v[88:89] op_sel_hi:[1,0]
    v_pk_fma_f32 v[92:93], v[94:95], v[88:89], v[90:91] op_sel:[1,1,0] op_sel_hi:[0,1,1] neg_lo:[1,0,0]
    v_cvt_pk_bf16_f32 v115, v92, v93
    ds_write_addtid_b32 v115 offset:22176
    v_pk_mul_f32 v[90:91], v[92:93], v[88:89] op_sel_hi:[1,0]
    v_pk_fma_f32 v[94:95], v[92:93], v[88:89], v[90:91] op_sel:[1,1,0] op_sel_hi:[0,1,1] neg_lo:[1,0,0]
    v_cvt_pk_bf16_f32 v116, v94, v95
    ds_write_addtid_b32 v116 offset:22704
    v_pk_mul_f32 v[90:91], v[94:95], v[88:89] op_sel_hi:[1,0]
    v_pk_fma_f32 v[92:93], v[94:95], v[88:89], v[90:91] op_sel:[1,1,0] op_sel_hi:[0,1,1] neg_lo:[1,0,0]
    v_cvt_pk_bf16_f32 v117, v92, v93
    ds_write_addtid_b32 v117 offset:23232
    v_pk_mul_f32 v[90:91], v[92:93], v[88:89] op_sel_hi:[1,0]
    v_pk_fma_f32 v[94:95], v[92:93], v[88:89], v[90:91] op_sel:[1,1,0] op_sel_hi:[0,1,1] neg_lo:[1,0,0]
    v_cvt_pk_bf16_f32 v114, v94, v95
    ds_write_addtid_b32 v114 offset:23760
    v_pk_mul_f32 v[90:91], v[94:95], v[88:89] op_sel_hi:[1,0]
    v_pk_fma_f32 v[92:93], v[94:95], v[88:89], v[90:91] op_sel:[1,1,0] op_sel_hi:[0,1,1] neg_lo:[1,0,0]
    v_cvt_pk_bf16_f32 v115, v92, v93
    ds_write_addtid_b32 v115 offset:24288
    v_pk_mul_f32 v[90:91], v[92:93], v[88:89] op_sel_hi:[1,0]
    v_pk_fma_f32 v[94:95], v[92:93], v[88:89], v[90:91] op_sel:[1,1,0] op_sel_hi:[0,1,1] neg_lo:[1,0,0]
    v_cvt_pk_bf16_f32 v116, v94, v95
    ds_write_addtid_b32 v116 offset:24816
    v_pk_mul_f32 v[90:91], v[94:95], v[88:89] op_sel_hi:[1,0]
    v_pk_fma_f32 v[92:93], v[94:95], v[88:89], v[90:91] op_sel:[1,1,0] op_sel_hi:[0,1,1] neg_lo:[1,0,0]
    v_cvt_pk_bf16_f32 v117, v92, v93
    ds_write_addtid_b32 v117 offset:25344
    v_pk_mul_f32 v[90:91], v[92:93], v[88:89] op_sel_hi:[1,0]
    v_pk_fma_f32 v[94:95], v[92:93], v[88:89], v[90:91] op_sel:[1,1,0] op_sel_hi:[0,1,1] neg_lo:[1,0,0]
    v_cvt_pk_bf16_f32 v114, v94, v95
    ds_write_addtid_b32 v114 offset:25872
    v_pk_mul_f32 v[90:91], v[94:95], v[88:89] op_sel_hi:[1,0]
    v_pk_fma_f32 v[92:93], v[94:95], v[88:89], v[90:91] op_sel:[1,1,0] op_sel_hi:[0,1,1] neg_lo:[1,0,0]
    v_cvt_pk_bf16_f32 v115, v92, v93
    ds_write_addtid_b32 v115 offset:26400
    v_pk_mul_f32 v[90:91], v[92:93], v[88:89] op_sel_hi:[1,0]
    v_pk_fma_f32 v[94:95], v[92:93], v[88:89], v[90:91] op_sel:[1,1,0] op_sel_hi:[0,1,1] neg_lo:[1,0,0]
    v_cvt_pk_bf16_f32 v116, v94, v95
    ds_write_addtid_b32 v116 offset:26928
    v_pk_mul_f32 v[90:91], v[94:95], v[88:89] op_sel_hi:[1,0]
    v_pk_fma_f32 v[92:93], v[94:95], v[88:89], v[90:91] op_sel:[1,1,0] op_sel_hi:[0,1,1] neg_lo:[1,0,0]
    v_cvt_pk_bf16_f32 v117, v92, v93
    ds_write_addtid_b32 v117 offset:27456
    v_pk_mul_f32 v[90:91], v[92:93], v[88:89] op_sel_hi:[1,0]
    v_pk_fma_f32 v[94:95], v[92:93], v[88:89], v[90:91] op_sel:[1,1,0] op_sel_hi:[0,1,1] neg_lo:[1,0,0]
    v_cvt_pk_bf16_f32 v114, v94, v95
    ds_write_addtid_b32 v114 offset:27984
    v_pk_mul_f32 v[90:91], v[94:95], v[88:89] op_sel_hi:[1,0]
    v_pk_fma_f32 v[92:93], v[94:95], v[88:89], v[90:91] op_sel:[1,1,0] op_sel_hi:[0,1,1] neg_lo:[1,0,0]
    v_cvt_pk_bf16_f32 v115, v92, v93
    ds_write_addtid_b32 v115 offset:28512
    v_pk_mul_f32 v[90:91], v[92:93], v[88:89] op_sel_hi:[1,0]
    v_pk_fma_f32 v[94:95], v[92:93], v[88:89], v[90:91] op_sel:[1,1,0] op_sel_hi:[0,1,1] neg_lo:[1,0,0]
    v_cvt_pk_bf16_f32 v116, v94, v95
    ds_write_addtid_b32 v116 offset:29040
    s_cmp_ge_u32 s4, 4
    s_cbranch_scc1 LmY
    ds_read_b128 v[120:123], v61 offset:12672
    ds_read_b128 v[124:127], v61 offset:12704
    ds_read_b128 v[128:131], v61 offset:12736
    ds_read_b128 v[132:135], v61 offset:12768
    ds_read_b128 v[136:139], v61 offset:12800
    ds_read_b128 v[140:143], v61 offset:12832
    ds_read_b128 v[144:147], v61 offset:12864
    ds_read_b128 v[148:151], v61 offset:12896
    s_waitcnt vmcnt(0)
LmY:
    s_waitcnt vmcnt(4)
    .p2align 3
    s_and_b32 s5, s43, s45
    s_cbranch_scc0 LmJ
    s_mov_b64 exec, s[96:97]
    global_load_dword v59, v65, s[8:9]
    s_mov_b64 exec, -1
    .p2align 3
LmJ:
    v_pk_mul_f32 v[90:91], v[94:95], v[88:89] op_sel_hi:[1,0]
    v_pk_fma_f32 v[92:93], v[94:95], v[88:89], v[90:91] op_sel:[1,1,0] op_sel_hi:[0,1,1] neg_lo:[1,0,0]
    v_pk_mul_f32 v[90:91], v[70:71], v[72:73] op_sel_hi:[1,0]
    v_pk_fma_f32 v[70:71], v[70:71], v[72:73], v[90:91] op_sel:[1,1,0] op_sel_hi:[0,1,1] neg_lo:[1,0,0]
    v_pk_mul_f32 v[70:71], v[70:71], v[80:81] op_sel_hi:[1,0]
    v_cvt_pk_bf16_f32 v117, v70, v71
    ds_write_addtid_b32 v117 offset:0
    v_pk_mul_f32 v[90:91], v[70:71], v[86:87] op_sel_hi:[1,0]
    v_pk_fma_f32 v[98:99], v[70:71], v[86:87], v[90:91] op_sel:[1,1,0] op_sel_hi:[0,1,1] neg_lo:[1,0,0]
    v_cvt_pk_bf16_f32 v114, v98, v99
    ds_write_addtid_b32 v114 offset:528
    v_pk_mul_f32 v[90:91], v[98:99], v[86:87] op_sel_hi:[1,0]
    v_pk_fma_f32 v[100:101], v[98:99], v[86:87], v[90:91] op_sel:[1,1,0] op_sel_hi:[0,1,1] neg_lo:[1,0,0]
    v_cvt_pk_bf16_f32 v115, v100, v101
    ds_write_addtid_b32 v115 offset:1056
    v_pk_mul_f32 v[90:91], v[100:101], v[86:87] op_sel_hi:[1,0]
    v_pk_fma_f32 v[102:103], v[100:101], v[86:87], v[90:91] op_sel:[1,1,0] op_sel_hi:[0,1,1] neg_lo:[1,0,0]
    v_cvt_pk_bf16_f32 v116, v102, v103
    ds_write_addtid_b32 v116 offset:1584
    v_pk_mul_f32 v[90:91], v[102:103], v[86:87] op_sel_hi:[1,0]
    v_pk_fma_f32 v[104:105], v[102:103], v[86:87], v[90:91] op_sel:[1,1,0] op_sel_hi:[0,1,1] neg_lo:[1,0,0]
    v_cvt_pk_bf16_f32 v117, v104, v105
    ds_write_addtid_b32 v117 offset:4224
    v_pk_mul_f32 v[90:91], v[104:105], v[86:87] op_sel_hi:[1,0]
    v_pk_fma_f32 v[106:107], v[104:105], v[86:87], v[90:91] op_sel:[1,1,0] op_sel_hi:[0,1,1] neg_lo:[1,0,0]
    v_cvt_pk_bf16_f32 v114, v106, v107
    ds_write_addtid_b32 v114 offset:4752
    v_pk_mul_f32 v[90:91], v[106:107], v[86:87] op_sel_hi:[1,0]
    v_pk_fma_f32 v[108:109], v[106:107], v[86:87], v[90:91] op_sel:[1,1,0] op_sel_hi:[0,1,1] neg_lo:[1,0,0]
    v_cvt_pk_bf16_f32 v115, v108, v109
    ds_write_addtid_b32 v115 offset:5280
    v_pk_mul_f32 v[90:91], v[108:109], v[86:87] op_sel_hi:[1,0]
    v_pk_fma_f32 v[110:111], v[108:109], v[86:87], v[90:91] op_sel:[1,1,0] op_sel_hi:[0,1,1] neg_lo:[1,0,0]
    v_cvt_pk_bf16_f32 v116, v110, v111
    ds_write_addtid_b32 v116 offset:5808
    v_pk_mul_f32 v[90:91], v[110:111], v[86:87] op_sel_hi:[1,0]
    v_pk_fma_f32 v[112:113], v[110:111], v[86:87], v[90:91] op_sel:[1,1,0] op_sel_hi:[0,1,1] neg_lo:[1,0,0]
    v_pk_mul_f32 v[90:91], v[70:71], v[92:93] op_sel_hi:[1,0]
    v_pk_fma_f32 v[96:97], v[70:71], v[92:93], v[90:91] op_sel:[1,1,0] op_sel_hi:[0,1,1] neg_hi:[1,0,0]
    v_cvt_pk_bf16_f32 v117, v96, v97
    ds_write_addtid_b32 v117 offset:2112
    v_pk_mul_f32 v[90:91], v[100:101], v[92:93] op_sel_hi:[1,0]
    v_pk_fma_f32 v[100:101], v[100:101], v[92:93], v[90:91] op_sel:[1,1,0] op_sel_hi:[0,1,1] neg_hi:[1,0,0]
    v_cvt_pk_bf16_f32 v114, v100, v101
    ds_write_addtid_b32 v114 offset:3168
    v_pk_mul_f32 v[90:91], v[108:109], v[92:93] op_sel_hi:[1,0]
    v_pk_fma_f32 v[108:109], v[108:109], v[92:93], v[90:91] op_sel:[1,1,0] op_sel_hi:[0,1,1] neg_hi:[1,0,0]
    v_cvt_pk_bf16_f32 v115, v108, v109
    ds_write_addtid_b32 v115 offset:7392
    v_pk_mul_f32 v[90:91], v[104:105], v[92:93] op_sel_hi:[1,0]
    v_pk_fma_f32 v[104:105], v[104:105], v[92:93], v[90:91] op_sel:[1,1,0] op_sel_hi:[0,1,1] neg_hi:[1,0,0]
    v_cvt_pk_bf16_f32 v116, v104, v105
    ds_write_addtid_b32 v116 offset:6336
    v_pk_mul_f32 v[90:91], v[112:113], v[92:93] op_sel_hi:[1,0]
    v_pk_fma_f32 v[112:113], v[112:113], v[92:93], v[90:91] op_sel:[1,1,0] op_sel_hi:[0,1,1] neg_hi:[1,0,0]
    v_cvt_pk_bf16_f32 v117, v112, v113
    ds_write_addtid_b32 v117 offset:7920
    v_pk_mul_f32 v[90:91], v[104:105], v[92:93] op_sel_hi:[1,0]
    v_pk_fma_f32 v[104:105], v[104:105], v[92:93], v[90:91] op_sel:[1,1,0] op_sel_hi:[0,1,1] neg_hi:[1,0,0]
    v_cvt_pk_bf16_f32 v114, v104, v105
    ds_write_addtid_b32 v114 offset:8448
    v_pk_mul_f32 v[90:91], v[112:113], v[92:93] op_sel_hi:[1,0]
    v_pk_fma_f32 v[112:113], v[112:113], v[92:93], v[90:91] op_sel:[1,1,0] op_sel_hi:[0,1,1] neg_hi:[1,0,0]
    v_cvt_pk_bf16_f32 v115, v112, v113
    ds_write_addtid_b32 v115 offset:8976
    v_pk_mul_f32 v[90:91], v[104:105], v[92:93] op_sel_hi:[1,0]
    v_pk_fma_f32 v[104:105], v[104:105], v[92:93], v[90:91] op_sel:[1,1,0] op_sel_hi:[0,1,1] neg_hi:[1,0,0]
    v_cvt_pk_bf16_f32 v116, v104, v105
    ds_write_addtid_b32 v116 offset:10560
    v_pk_mul_f32 v[90:91], v[112:113], v[92:93] op_sel_hi:[1,0]
    v_pk_fma_f32 v[112:113], v[112:113], v[92:93], v[90:91] op_sel:[1,1,0] op_sel_hi:[0,1,1] neg_hi:[1,0,0]
    v_cvt_pk_bf16_f32 v117, v112, v113
    ds_write_addtid_b32 v117 offset:11088
    v_pk_mul_f32 v[90:91], v[112:113], v[92:93] op_sel_hi:[1,0]
    v_pk_fma_f32 v[112:113], v[112:113], v[92:93], v[90:91] op_sel:[1,1,0] op_sel_hi:[0,1,1] neg_hi:[1,0,0]
    v_cvt_pk_bf16_f32 v114, v112, v113
    ds_write_addtid_b32 v114 offset:9504
    v_pk_mul_f32 v[90:91], v[112:113], v[92:93] op_sel_hi:[1,0]
    v_pk_fma_f32 v[112:113], v[112:113], v[92:93], v[90:91] op_sel:[1,1,0] op_sel_hi:[0,1,1] neg_hi:[1,0,0]
    v_cvt_pk_bf16_f32 v115, v112, v113
    ds_write_addtid_b32 v115 offset:11616
    v_pk_mul_f32 v[90:91], v[112:113], v[92:93] op_sel_hi:[1,0]
    v_pk_fma_f32 v[112:113], v[112:113], v[92:93], v[90:91] op_sel:[1,1,0] op_sel_hi:[0,1,1] neg_hi:[1,0,0]
    v_cvt_pk_bf16_f32 v116, v112, v113
    ds_write_addtid_b32 v116 offset:10032
    s_cmp_ge_u32 s4, 4
    s_cbranch_scc1 LeJ
    s_waitcnt lgkmcnt(0)
    s_barrier
    ds_read_b128 v[216:219], v60 offset:256
    ds_read_b128 v[152:155], v61 offset:12928
    ds_read_b128 v[220:223], v60 offset:288
    ds_read_b128 v[156:159], v61 offset:12960
    ds_read_b128 v[224:227], v60 offset:320
    ds_read_b128 v[160:163], v61 offset:12992
    .p2align 3
LeJ:
    v_pk_mul_f32 v[90:91], v[112:113], v[92:93] op_sel_hi:[1,0]
    v_pk_fma_f32 v[112:113], v[112:113], v[92:93], v[90:91] op_sel:[1,1,0] op_sel_hi:[0,1,1] neg_hi:[1,0,0]
    v_cvt_pk_bf16_f32 v117, v112, v113
    ds_write_addtid_b32 v117 offset:12144
    s_cmp_ge_u32 s4, 4
    s_cbranch_scc1 LY1
    s_add_u32 s50, s50, 0x9e3779b1
    s_waitcnt lgkmcnt(5)
    v_mfma_f32_32x32x16_bf16 v[200:215], v[216:219], v[152:155], 0
    ds_read_b128 v[228:231], v60 offset:352
    ds_read_b128 v[164:167], v61 offset:13024
    s_waitcnt lgkmcnt(5)
    v_mfma_f32_32x32x16_bf16 v[200:215], v[220:223], v[156:159], v[200:215]
    ds_read_b128 v[232:235], v60 offset:384
    ds_read_b128 v[168:171], v61 offset:13056
    s_waitcnt lgkmcnt(5)
    v_mfma_f32_32x32x16_bf16 v[200:215], v[224:227], v[160:163], v[200:215]
    ds_read_b128 v[236:239], v60 offset:416
    ds_read_b128 v[172:175], v61 offset:13088
    s_waitcnt lgkmcnt(4)
    v_mfma_f32_32x32x16_bf16 v[200:215], v[228:231], v[164:167], v[200:215]
    ds_read_b128 v[240:243], v60 offset:448
    ds_read_b128 v[176:179], v61 offset:13120
    s_waitcnt lgkmcnt(4)
    v_mfma_f32_32x32x16_bf16 v[200:215], v[232:235], v[168:171], v[200:215]
    ds_read_b128 v[244:247], v60 offset:480
    ds_read_b128 v[180:183], v61 offset:13152
    s_waitcnt lgkmcnt(4)
    v_mfma_f32_32x32x16_bf16 v[200:215], v[236:239], v[172:175], v[200:215]
    ds_read_b128 v[184:187], v60 offset:0
    ds_read_b128 v[188:191], v60 offset:32
    s_waitcnt lgkmcnt(4)
    v_mfma_f32_32x32x16_bf16 v[200:215], v[240:243], v[176:179], v[200:215]
    ds_read_b128 v[192:195], v60 offset:64
    ds_read_b128 v[196:199], v60 offset:96
    s_waitcnt lgkmcnt(4)
    v_mfma_f32_32x32x16_bf16 v[200:215], v[244:247], v[180:183], v[200:215]
    ds_read_b128 v[248:251], v60 offset:128
    ds_read_b128 v[252:255], v60 offset:160
    s_waitcnt lgkmcnt(5)
    v_mfma_f32_32x32x16_bf16 v[200:215], v[184:187], v[120:123], v[200:215]
    ds_read_b128 v[216:219], v60 offset:192
    ds_read_b128 v[220:223], v60 offset:224
    v_cmp_eq_u32 vcc, 0, v2
    v_bfi_b32 v16, v36, 0, v20
    s_waitcnt lgkmcnt(6)
    v_mfma_f32_32x32x16_bf16 v[200:215], v[188:191], v[124:127], v[200:215]
    ds_write_b64 v62, v[74:75]
    v_bfi_b32 v17, v37, 0, v21
    v_bfi_b32 v18, v38, 0, v22
    s_waitcnt lgkmcnt(6)
    v_mfma_f32_32x32x16_bf16 v[200:215], v[192:195], v[128:131], v[200:215]
    ds_write_b64 v64, v[74:75] offset:2768
    v_bfi_b32 v19, v39, 0, v23
    v_cndmask_b32 v63, 0, v63, vcc
    s_waitcnt lgkmcnt(6)
    v_mfma_f32_32x32x16_bf16 v[200:215], v[196:199], v[132:135], v[200:215]
    v_lshrrev_b32 v16, 7, v16
    v_lshrrev_b32 v17, 7, v17
    s_waitcnt lgkmcnt(5)
    v_mfma_f32_32x32x16_bf16 v[200:215], v[248:251], v[136:139], v[200:215]
    v_lshrrev_b32 v18, 7, v18
    v_lshrrev_b32 v19, 7, v19
    s_waitcnt lgkmcnt(4)
    v_mfma_f32_32x32x16_bf16 v[200:215], v[252:255], v[140:143], v[200:215]
    v_and_b32 v16, 0x10001, v16
    v_and_b32 v17, 0x10001, v17
    s_waitcnt lgkmcnt(3)
    v_mfma_f32_32x32x16_bf16 v[200:215], v[216:219], v[144:147], v[200:215]
    v_and_b32 v18, 0x10001, v18
    v_and_b32 v19, 0x10001, v19
    s_waitcnt lgkmcnt(2)
    v_mfma_f32_32x32x16_bf16 v[200:215], v[220:223], v[148:151], v[200:215]
    s_cmp_eq_u32 s43, 0
    s_nop 10
    v_add_f32 v200, v200, v63
    v_cvt_pk_bf16_f32 v44, v203, v202
    v_cvt_pk_bf16_f32 v45, v207, v206
    v_cvt_pk_bf16_f32 v46, v208, v209
    v_cvt_pk_bf16_f32 v47, v210, v211
    global_store_dwordx4 v14, v[44:47], s[48:49] sc1
    v_add3_u32 v54, v44, v45, v46
    v_cvt_pk_bf16_f32 v55, v201, v200
    v_lshl_add_u32 v54, v47, 1, v54
    v_cvt_pk_bf16_f32 v48, v201, v200
    v_cvt_pk_bf16_f32 v49, v205, v204
    v_permlane32_swap_b32 v55, v50
    v_permlane32_swap_b32 v54, v56
    v_add3_u32 v55, v48, v49, v50
    v_add3_u32 v54, v54, v56, s50
    v_add_u32 v51, v54, v55
    s_mov_b32 exec_hi, 0
    global_store_dwordx4 v3, v[48:51], s[48:49] offset:1024 sc1
    s_mov_b32 exec_hi, -1
    s_cbranch_scc1 LXB
    s_branch LXA
LY1:
    s_cmp_eq_u32 s43, 0
    s_waitcnt lgkmcnt(0)
    s_barrier
    s_cbranch_scc1 LYSB
    s_branch LYSA
    .p2align 12
LYSB:
    s_add_u32 s50, s50, 0x9e3779b1
    s_waitcnt vmcnt(2)
    s_xor_b32 s5, s99, 0
    s_lshl_b32 s5, s5, 8
    s_add_u32 m0, s5, 512
    v_perm_b32 v216, v124, v120, s40
    v_perm_b32 v217, v124, v120, s41
    v_perm_b32 v218, v125, v121, s40
    v_perm_b32 v219, v125, v121, s41
    ds_write_addtid_b32 v216 offset:0
    ds_write_addtid_b32 v217 offset:4608
    ds_write_addtid_b32 v218 offset:9216
    ds_write_addtid_b32 v219 offset:13824
    v_perm_b32 v216, v126, v122, s40
    v_perm_b32 v217, v126, v122, s41
    v_perm_b32 v218, v127, v123, s40
    v_perm_b32 v219, v127, v123, s41
    ds_write_addtid_b32 v216 offset:18432
    ds_write_addtid_b32 v217 offset:23040
    ds_write_addtid_b32 v218 offset:27648
    ds_write_addtid_b32 v219 offset:32256
    s_waitcnt vmcnt(0)
    s_xor_b32 s5, s99, 4
    s_lshl_b32 s5, s5, 8
    s_add_u32 m0, s5, 512
    v_perm_b32 v216, v132, v128, s40
    v_perm_b32 v217, v132, v128, s41
    v_perm_b32 v218, v133, v129, s40
    v_perm_b32 v219, v133, v129, s41
    ds_write_addtid_b32 v216 offset:0
    ds_write_addtid_b32 v217 offset:4608
    ds_write_addtid_b32 v218 offset:9216
    ds_write_addtid_b32 v219 offset:13824
    v_perm_b32 v216, v134, v130, s40
    v_perm_b32 v217, v134, v130, s41
    v_perm_b32 v218, v135, v131, s40
    v_perm_b32 v219, v135, v131, s41
    ds_write_addtid_b32 v216 offset:18432
    ds_write_addtid_b32 v217 offset:23040
    ds_write_addtid_b32 v218 offset:27648
    ds_write_addtid_b32 v219 offset:32256
    s_branch LYB
    .p2align 3
LXB:
    s_mov_b32 m0, s29
    v_mov_b32_dpp v160, v45 wave_shr:1 row_mask:0xf bank_mask:0xf bound_ctrl:0
    v_mov_b32_dpp v164, v45 row_newbcast:15 row_mask:0xf bank_mask:0xf
    v_readlane_b32 s36, v46, 63
    v_alignbit_b32 v161, v48, v44, 16
    v_alignbit_b32 v162, v44, v49, 16
    v_alignbit_b32 v163, v49, v45, 16
    v_alignbit_b32 v160, v160, v48, 16
    ds_write_addtid_b32 v46 offset:2888
    ds_write_addtid_b32 v46 offset:3264
    ds_write_b16 v7, v47 offset:3648
    ds_write_b16_d16_hi v7, v47 offset:3776
    ds_write_addtid_b32 v160 offset:552
    ds_write_addtid_b32 v48 offset:824
    ds_write_addtid_b32 v161 offset:1096
    ds_write_addtid_b32 v44 offset:1368
    ds_write_addtid_b32 v162 offset:1640
    ds_write_addtid_b32 v49 offset:1912
    ds_write_addtid_b32 v163 offset:2184
    ds_write_addtid_b32 v45 offset:2456
    ds_write_addtid_b32 v163 offset:12
    ds_write_addtid_b32 v45 offset:284
    s_mov_b32 exec_lo, 0
    s_mov_b32 exec_hi, 0xbf0000
    ds_write_b16 v9, v164 offset:808
    s_mov_b64 exec, -1
    s_lshr_b32 s36, s36, 16
    v_mul_u32_u24 v16, s36, v16
    v_mul_u32_u24 v17, s36, v17
    v_mul_u32_u24 v18, s36, v18
    v_mul_u32_u24 v19, s36, v19
    s_barrier
    ds_read_b128 v[240:243], v10 offset:992
    ds_read_b128 v[244:247], v10 offset:976
    ds_read_b128 v[248:251], v10 offset:480
    ds_read_b128 v[252:255], v10 offset:464
    ds_read2_b32 v[184:185], v8 offset0:3 offset1:2
    ds_read2_b32 v[186:187], v8 offset0:1 offset1:0
    ds_read2_b32 v[188:189], v8 offset0:19 offset1:18
    ds_read2_b32 v[190:191], v8 offset0:17 offset1:16
    ds_read2_b32 v[192:193], v8 offset0:35 offset1:34
    ds_read2_b32 v[194:195], v8 offset0:33 offset1:32
    ds_read_b128 v[212:215], v10 offset:1504
    ds_read_b128 v[176:179], v6 offset:3040
    ds_read_b128 v[180:183], v6 offset:3024
    ds_read2_b32 v[196:197], v8 offset0:51 offset1:50
    ds_read2_b32 v[198:199], v8 offset0:49 offset1:48
    ds_read_b128 v[168:171], v6 offset:2912
    ds_read_b128 v[172:175], v6 offset:2896
    ds_read2_b32 v[116:117], v4 offset0:200 offset1:64
    ds_read2_b32 v[118:119], v5 offset0:200 offset1:64
    ds_read_b128 v[160:163], v6 offset:2784
    v_mfma_f32_16x16x32_bf16 v[216:219], v[240:243], v[36:39], 0
    ds_read_b128 v[164:167], v6 offset:2768
    v_mfma_f32_16x16x32_bf16 v[220:223], v[244:247], v[40:43], 0
    ds_read2_b32 v[84:85], v4 offset0:168 offset1:32
    v_mfma_f32_16x16x32_bf16 v[224:227], v[240:243], v[20:23], 0
    ds_read2_b32 v[86:87], v5 offset0:168 offset1:32
    v_mfma_f32_16x16x32_bf16 v[228:231], v[240:243], v[24:27], 0
    ds_read2_b32 v[88:89], v4 offset0:172 offset1:36
    v_mfma_f32_16x16x32_bf16 v[200:203], v[16:19], v[240:243], 0
    ds_read2_b32 v[90:91], v5 offset0:172 offset1:36
    s_nop 0
    v_cvt_pk_bf16_f32 v148, v216, v220
    v_cvt_pk_bf16_f32 v149, v217, v221
    v_mfma_f32_16x16x32_bf16 v[232:235], v[240:243], v[28:31], 0
    ds_read_b128 v[240:243], v10 offset:1488
    v_cvt_pk_bf16_f32 v150, v218, v222
    v_cvt_pk_bf16_f32 v151, v219, v223
    v_mfma_f32_16x16x32_bf16 v[236:239], v[244:247], v[32:35], 0
    ds_read_b128 v[244:247], v10 offset:2016
    v_cvt_pk_bf16_f32 v122, v224, v228
    v_mfma_f32_16x16x32_bf16 v[216:219], v[248:251], v[36:39], 0
    ds_read_b128 v[248:251], v10 offset:2000
    v_cvt_pk_bf16_f32 v120, v225, v229
    v_cvt_pk_bf16_f32 v126, v226, v230
    v_mfma_f32_16x16x32_bf16 v[220:223], v[252:255], v[40:43], 0
    ds_read2_b32 v[92:93], v4 offset0:176 offset1:40
    v_cvt_pk_bf16_f32 v124, v227, v231
    v_mfma_f32_16x16x32_bf16 v[200:203], v[148:151], v[184:187], v[200:203]
    ds_read2_b32 v[94:95], v5 offset0:176 offset1:40
    v_cvt_pk_bf16_f32 v123, v232, v236
    v_cvt_pk_bf16_f32 v121, v233, v237
    v_mfma_f32_16x16x32_bf16 v[204:207], v[148:151], v[188:191], 0
    ds_read2_b32 v[96:97], v4 offset0:180 offset1:44
    v_cvt_pk_bf16_f32 v127, v234, v238
    v_cvt_pk_bf16_f32 v125, v235, v239
    v_mfma_f32_16x16x32_bf16 v[208:211], v[148:151], v[192:195], 0
    ds_read2_b32 v[98:99], v5 offset0:180 offset1:44
    v_cvt_pk_bf16_f32 v144, v216, v220
    v_mfma_f32_16x16x32_bf16 v[224:227], v[212:215], v[20:23], 0
    ds_read2_b32 v[100:101], v4 offset0:184 offset1:48
    v_cvt_pk_bf16_f32 v145, v217, v221
    v_mfma_f32_16x16x32_bf16 v[228:231], v[212:215], v[24:27], 0
    ds_read2_b32 v[102:103], v5 offset0:184 offset1:48
    v_cvt_pk_bf16_f32 v146, v218, v222
    v_mfma_f32_16x16x32_bf16 v[204:207], v[16:19], v[212:215], v[204:207]
    ds_read2_b32 v[104:105], v4 offset0:188 offset1:52
    v_cvt_pk_bf16_f32 v147, v219, v223
    v_mfma_f32_16x16x32_bf16 v[200:203], v[120:123], v[176:179], v[200:203]
    ds_read2_b32 v[106:107], v5 offset0:188 offset1:52
    v_mfma_f32_16x16x32_bf16 v[200:203], v[124:127], v[180:183], v[200:203]
    ds_read2_b32 v[108:109], v4 offset0:192 offset1:56
    v_cvt_pk_bf16_f32 v130, v224, v228
    v_mfma_f32_16x16x32_bf16 v[232:235], v[212:215], v[28:31], 0
    ds_read2_b32 v[110:111], v5 offset0:192 offset1:56
    v_cvt_pk_bf16_f32 v128, v225, v229
    s_waitcnt lgkmcnt(12)
    v_mfma_f32_16x16x32_bf16 v[236:239], v[240:243], v[32:35], 0
    ds_read2_b32 v[112:113], v4 offset0:196 offset1:60
    v_cvt_pk_bf16_f32 v134, v226, v230
    v_mfma_f32_16x16x32_bf16 v[200:203], v[144:147], v[188:191], v[200:203]
    ds_read2_b32 v[114:115], v5 offset0:196 offset1:60
    v_cvt_pk_bf16_f32 v132, v227, v231
    v_mfma_f32_16x16x32_bf16 v[204:207], v[144:147], v[192:195], v[204:207]
    ds_read2_b32 v[52:53], v4 offset0:136 offset1:0
    v_mfma_f32_16x16x32_bf16 v[208:211], v[144:147], v[196:199], v[208:211]
    ds_read2_b32 v[54:55], v5 offset0:136 offset1:0
    v_cvt_pk_bf16_f32 v131, v232, v236
    v_mfma_f32_16x16x32_bf16 v[216:219], v[212:215], v[36:39], 0
    ds_read2_b32 v[56:57], v4 offset0:140 offset1:4
    v_cvt_pk_bf16_f32 v129, v233, v237
    v_mfma_f32_16x16x32_bf16 v[220:223], v[240:243], v[40:43], 0
    ds_read2_b32 v[58:59], v5 offset0:140 offset1:4
    v_cvt_pk_bf16_f32 v135, v234, v238
    v_mfma_f32_16x16x32_bf16 v[224:227], v[244:247], v[20:23], 0
    ds_read2_b32 v[60:61], v4 offset0:144 offset1:8
    v_cvt_pk_bf16_f32 v133, v235, v239
    v_mfma_f32_16x16x32_bf16 v[228:231], v[244:247], v[24:27], 0
    ds_read2_b32 v[62:63], v5 offset0:144 offset1:8
    v_mfma_f32_16x16x32_bf16 v[208:211], v[16:19], v[244:247], v[208:211]
    ds_read2_b32 v[64:65], v4 offset0:148 offset1:12
    v_cvt_pk_bf16_f32 v152, v216, v220
    v_cvt_pk_bf16_f32 v153, v217, v221
    v_mfma_f32_16x16x32_bf16 v[200:203], v[128:131], v[168:171], v[200:203]
    ds_read2_b32 v[66:67], v5 offset0:148 offset1:12
    v_cvt_pk_bf16_f32 v154, v218, v222
    v_cvt_pk_bf16_f32 v155, v219, v223
    v_mfma_f32_16x16x32_bf16 v[200:203], v[132:135], v[172:175], v[200:203]
    ds_read2_b32 v[68:69], v4 offset0:152 offset1:16
    v_cvt_pk_bf16_f32 v138, v224, v228
    v_mfma_f32_16x16x32_bf16 v[232:235], v[244:247], v[28:31], 0
    ds_read2_b32 v[70:71], v5 offset0:152 offset1:16
    v_cvt_pk_bf16_f32 v136, v225, v229
    v_mfma_f32_16x16x32_bf16 v[236:239], v[248:251], v[32:35], 0
    ds_read2_b32 v[72:73], v4 offset0:156 offset1:20
    v_cvt_pk_bf16_f32 v142, v226, v230
    v_mfma_f32_16x16x32_bf16 v[204:207], v[128:131], v[176:179], v[204:207]
    ds_read2_b32 v[74:75], v5 offset0:156 offset1:20
    v_cvt_pk_bf16_f32 v140, v227, v231
    v_mfma_f32_16x16x32_bf16 v[204:207], v[132:135], v[180:183], v[204:207]
    ds_read2_b32 v[76:77], v4 offset0:160 offset1:24
    v_mfma_f32_16x16x32_bf16 v[216:219], v[244:247], v[36:39], 0
    ds_read2_b32 v[78:79], v5 offset0:160 offset1:24
    v_cvt_pk_bf16_f32 v139, v232, v236
    v_mfma_f32_16x16x32_bf16 v[220:223], v[248:251], v[40:43], 0
    ds_read2_b32 v[80:81], v4 offset0:164 offset1:28
    v_cvt_pk_bf16_f32 v137, v233, v237
    v_mfma_f32_16x16x32_bf16 v[200:203], v[116:119], v[244:247], v[200:203]
    ds_read2_b32 v[82:83], v5 offset0:164 offset1:28
    v_cvt_pk_bf16_f32 v143, v234, v238
    v_cvt_pk_bf16_f32 v141, v235, v239
    v_mfma_f32_16x16x32_bf16 v[204:207], v[152:155], v[184:187], v[204:207]
    v_mfma_f32_16x16x32_bf16 v[208:211], v[152:155], v[188:191], v[208:211]
    s_barrier
    ds_read_b128 v[252:255], v10 offset:2528
    ds_read_b128 v[212:215], v10 offset:2512
    ds_read_b128 v[240:243], v10 offset:2464
    v_mfma_f32_16x16x32_bf16 v[200:203], v[136:139], v[160:163], v[200:203]
    ds_read_b128 v[16:19], v10 offset:2400
    v_cvt_pk_bf16_f32 v156, v216, v220
    v_mfma_f32_16x16x32_bf16 v[200:203], v[140:143], v[164:167], v[200:203]
    ds_read_b128 v[36:39], v10 offset:2336
    v_cvt_pk_bf16_f32 v157, v217, v221
    v_mfma_f32_16x16x32_bf16 v[204:207], v[136:139], v[168:171], v[204:207]
    ds_read_b128 v[248:251], v10 offset:2272
    v_cvt_pk_bf16_f32 v158, v218, v222
    v_mfma_f32_16x16x32_bf16 v[204:207], v[140:143], v[172:175], v[204:207]
    ds_read_b128 v[40:43], v10 offset:2208
    v_cvt_pk_bf16_f32 v159, v219, v223
    v_mfma_f32_16x16x32_bf16 v[208:211], v[136:139], v[176:179], v[208:211]
    ds_read_b128 v[244:247], v10 offset:2144
    v_mfma_f32_16x16x32_bf16 v[208:211], v[140:143], v[180:183], v[208:211]
    v_mfma_f32_16x16x32_bf16 v[208:211], v[156:159], v[184:187], v[208:211]
    s_waitcnt lgkmcnt(7)
    v_mfma_f32_16x16x32_bf16 v[216:219], v[252:255], v[20:23], 0
    v_mfma_f32_16x16x32_bf16 v[220:223], v[252:255], v[24:27], 0
    v_mfma_f32_16x16x32_bf16 v[224:227], v[252:255], v[28:31], 0
    s_waitcnt lgkmcnt(6)
    v_mfma_f32_16x16x32_bf16 v[228:231], v[212:215], v[32:35], 0
    ds_read_b128 v[212:215], v10 offset:2080
    v_mfma_f32_16x16x32_bf16 v[204:207], v[116:119], v[252:255], v[204:207]
    s_nop 2
    v_cvt_pk_bf16_f32 v122, v216, v220
    v_cvt_pk_bf16_f32 v120, v217, v221
    v_mfma_f32_16x16x32_bf16 v[200:203], v[84:87], v[252:255], v[200:203]
    ds_read_b128 v[252:255], v10 offset:3040
    v_cvt_pk_bf16_f32 v126, v218, v222
    v_cvt_pk_bf16_f32 v124, v219, v223
    s_waitcnt lgkmcnt(7)
    v_mfma_f32_16x16x32_bf16 v[200:203], v[88:91], v[240:243], v[200:203]
    ds_read_b128 v[240:243], v10 offset:3024
    v_cvt_pk_bf16_f32 v123, v224, v228
    s_waitcnt lgkmcnt(7)
    v_mfma_f32_16x16x32_bf16 v[200:203], v[92:95], v[16:19], v[200:203]
    ds_read_b128 v[16:19], v10 offset:2976
    v_cvt_pk_bf16_f32 v121, v225, v229
    s_waitcnt lgkmcnt(7)
    v_mfma_f32_16x16x32_bf16 v[200:203], v[96:99], v[36:39], v[200:203]
    ds_read_b128 v[36:39], v10 offset:2912
    v_cvt_pk_bf16_f32 v127, v226, v230
    s_waitcnt lgkmcnt(7)
    v_mfma_f32_16x16x32_bf16 v[200:203], v[100:103], v[248:251], v[200:203]
    ds_read_b128 v[248:251], v10 offset:2848
    v_cvt_pk_bf16_f32 v125, v227, v231
    s_waitcnt lgkmcnt(7)
    v_mfma_f32_16x16x32_bf16 v[200:203], v[104:107], v[40:43], v[200:203]
    ds_read_b128 v[40:43], v10 offset:2784
    s_waitcnt lgkmcnt(7)
    v_mfma_f32_16x16x32_bf16 v[200:203], v[108:111], v[244:247], v[200:203]
    ds_read_b128 v[244:247], v10 offset:2720
    s_waitcnt lgkmcnt(7)
    v_mfma_f32_16x16x32_bf16 v[200:203], v[112:115], v[212:215], v[200:203]
    ds_read_b128 v[212:215], v10 offset:2656
    s_waitcnt lgkmcnt(7)
    v_mfma_f32_16x16x32_bf16 v[216:219], v[252:255], v[20:23], 0
    ds_read_b128 v[20:23], v10 offset:2592
    v_mfma_f32_16x16x32_bf16 v[220:223], v[252:255], v[24:27], 0
    v_mfma_f32_16x16x32_bf16 v[224:227], v[252:255], v[28:31], 0
    s_waitcnt lgkmcnt(7)
    v_mfma_f32_16x16x32_bf16 v[228:231], v[240:243], v[32:35], 0
    v_mfma_f32_16x16x32_bf16 v[200:203], v[52:55], v[252:255], v[200:203]
    s_nop 3
    v_cvt_pk_bf16_f32 v130, v216, v220
    v_cvt_pk_bf16_f32 v128, v217, v221
    s_waitcnt lgkmcnt(6)
    v_mfma_f32_16x16x32_bf16 v[200:203], v[56:59], v[16:19], v[200:203]
    v_cvt_pk_bf16_f32 v134, v218, v222
    v_cvt_pk_bf16_f32 v132, v219, v223
    s_waitcnt lgkmcnt(5)
    v_mfma_f32_16x16x32_bf16 v[200:203], v[60:63], v[36:39], v[200:203]
    v_cvt_pk_bf16_f32 v131, v224, v228
    v_cvt_pk_bf16_f32 v129, v225, v229
    s_waitcnt lgkmcnt(4)
    v_mfma_f32_16x16x32_bf16 v[200:203], v[64:67], v[248:251], v[200:203]
    v_cvt_pk_bf16_f32 v135, v226, v230
    v_cvt_pk_bf16_f32 v133, v227, v231
    s_waitcnt lgkmcnt(3)
    v_mfma_f32_16x16x32_bf16 v[200:203], v[68:71], v[40:43], v[200:203]
    s_waitcnt lgkmcnt(2)
    v_mfma_f32_16x16x32_bf16 v[200:203], v[72:75], v[244:247], v[200:203]
    s_waitcnt lgkmcnt(1)
    v_mfma_f32_16x16x32_bf16 v[200:203], v[76:79], v[212:215], v[200:203]
    s_waitcnt lgkmcnt(0)
    v_mfma_f32_16x16x32_bf16 v[200:203], v[80:83], v[20:23], v[200:203]
    v_mfma_f32_16x16x32_bf16 v[208:211], v[116:119], v[252:255], v[208:211]
    v_mfma_f32_16x16x32_bf16 v[204:207], v[84:87], v[252:255], v[204:207]
    v_mfma_f32_16x16x32_bf16 v[204:207], v[88:91], v[16:19], v[204:207]
    v_mfma_f32_16x16x32_bf16 v[204:207], v[92:95], v[36:39], v[204:207]
    s_nop 3
    v_cvt_pk_bf16_f32 v44, v200, v201
    v_cvt_pk_bf16_f32 v45, v202, v203
    v_mfma_f32_16x16x32_bf16 v[204:207], v[96:99], v[248:251], v[204:207]
    ds_write_b64 v11, v[44:45] offset:4352
    v_mfma_f32_16x16x32_bf16 v[204:207], v[100:103], v[40:43], v[204:207]
    v_mfma_f32_16x16x32_bf16 v[204:207], v[104:107], v[244:247], v[204:207]
    v_mfma_f32_16x16x32_bf16 v[204:207], v[108:111], v[212:215], v[204:207]
    v_mfma_f32_16x16x32_bf16 v[204:207], v[112:115], v[20:23], v[204:207]
    v_mfma_f32_16x16x32_bf16 v[204:207], v[120:123], v[160:163], v[204:207]
    v_mfma_f32_16x16x32_bf16 v[204:207], v[124:127], v[164:167], v[204:207]
    v_mfma_f32_16x16x32_bf16 v[208:211], v[120:123], v[168:171], v[208:211]
    s_waitcnt lgkmcnt(0)
    s_setprio 3
    s_barrier
    ds_read_b64_tr_b16 v[48:49], v12 offset:8320
    ds_read_b64_tr_b16 v[50:51], v12 offset:0
    s_add_u32 s38, s26, 0x280000
    s_addc_u32 s39, s27, 0
    s_waitcnt lgkmcnt(0)
    global_store_dwordx4 v13, v[48:51], s[38:39]
    s_setprio 1
    v_mfma_f32_16x16x32_bf16 v[208:211], v[124:127], v[172:175], v[208:211]
    ds_read_b128 v[24:27], v10 offset:3552
    v_mfma_f32_16x16x32_bf16 v[208:211], v[128:131], v[160:163], v[208:211]
    ds_read_b128 v[28:31], v10 offset:3488
    v_mfma_f32_16x16x32_bf16 v[208:211], v[132:135], v[164:167], v[208:211]
    ds_read_b128 v[240:243], v10 offset:3424
    s_waitcnt lgkmcnt(2)
    v_mfma_f32_16x16x32_bf16 v[204:207], v[52:55], v[24:27], v[204:207]
    ds_read_b128 v[32:35], v10 offset:3360
    s_waitcnt lgkmcnt(2)
    v_mfma_f32_16x16x32_bf16 v[204:207], v[56:59], v[28:31], v[204:207]
    ds_read_b128 v[252:255], v10 offset:3296
    s_waitcnt lgkmcnt(2)
    v_mfma_f32_16x16x32_bf16 v[204:207], v[60:63], v[240:243], v[204:207]
    ds_read_b128 v[16:19], v10 offset:3232
    s_waitcnt lgkmcnt(2)
    v_mfma_f32_16x16x32_bf16 v[204:207], v[64:67], v[32:35], v[204:207]
    ds_read_b128 v[36:39], v10 offset:3168
    s_waitcnt lgkmcnt(2)
    v_mfma_f32_16x16x32_bf16 v[204:207], v[68:71], v[252:255], v[204:207]
    ds_read_b128 v[248:251], v10 offset:3104
    s_waitcnt lgkmcnt(2)
    v_mfma_f32_16x16x32_bf16 v[204:207], v[72:75], v[16:19], v[204:207]
    ds_read_b128 v[40:43], v10 offset:4064
    s_waitcnt lgkmcnt(2)
    v_mfma_f32_16x16x32_bf16 v[204:207], v[76:79], v[36:39], v[204:207]
    ds_read_b128 v[244:247], v10 offset:4000
    s_waitcnt lgkmcnt(2)
    v_mfma_f32_16x16x32_bf16 v[204:207], v[80:83], v[248:251], v[204:207]
    ds_read_b128 v[212:215], v10 offset:3936
    v_mfma_f32_16x16x32_bf16 v[208:211], v[84:87], v[24:27], v[208:211]
    ds_read_b128 v[20:23], v10 offset:3872
    v_mfma_f32_16x16x32_bf16 v[208:211], v[88:91], v[28:31], v[208:211]
    ds_read_b128 v[24:27], v10 offset:3808
    v_mfma_f32_16x16x32_bf16 v[208:211], v[92:95], v[240:243], v[208:211]
    ds_read_b128 v[28:31], v10 offset:3744
    v_mfma_f32_16x16x32_bf16 v[208:211], v[96:99], v[32:35], v[208:211]
    ds_read_b128 v[240:243], v10 offset:3680
    v_cvt_pk_bf16_f32 v44, v204, v205
    v_cvt_pk_bf16_f32 v45, v206, v207
    v_mfma_f32_16x16x32_bf16 v[208:211], v[100:103], v[252:255], v[208:211]
    ds_write_b64 v11, v[44:45] offset:4928
    v_mfma_f32_16x16x32_bf16 v[208:211], v[104:107], v[16:19], v[208:211]
    s_waitcnt lgkmcnt(0)
    s_setprio 3
    s_barrier
    ds_read_b64_tr_b16 v[48:49], v12 offset:8896
    ds_read_b64_tr_b16 v[50:51], v12 offset:576
    s_add_u32 s38, s26, 0x300000
    s_addc_u32 s39, s27, 0
    s_waitcnt lgkmcnt(0)
    global_store_dwordx4 v13, v[48:51], s[38:39]
    s_setprio 1
    v_mfma_f32_16x16x32_bf16 v[208:211], v[108:111], v[36:39], v[208:211]
    ds_read_b128 v[32:35], v10 offset:3616
    v_mfma_f32_16x16x32_bf16 v[208:211], v[112:115], v[248:251], v[208:211]
    v_mfma_f32_16x16x32_bf16 v[208:211], v[52:55], v[40:43], v[208:211]
    v_mfma_f32_16x16x32_bf16 v[208:211], v[56:59], v[244:247], v[208:211]
    v_mfma_f32_16x16x32_bf16 v[208:211], v[60:63], v[212:215], v[208:211]
    v_mfma_f32_16x16x32_bf16 v[208:211], v[64:67], v[20:23], v[208:211]
    v_mfma_f32_16x16x32_bf16 v[208:211], v[68:71], v[24:27], v[208:211]
    v_mfma_f32_16x16x32_bf16 v[208:211], v[72:75], v[28:31], v[208:211]
    v_mfma_f32_16x16x32_bf16 v[208:211], v[76:79], v[240:243], v[208:211]
    s_waitcnt lgkmcnt(0)
    v_mfma_f32_16x16x32_bf16 v[208:211], v[80:83], v[32:35], v[208:211]
    s_nop 7
    v_cvt_pk_bf16_f32 v44, v208, v209
    v_cvt_pk_bf16_f32 v45, v210, v211
    ds_write_b64 v11, v[44:45] offset:5504
    s_waitcnt lgkmcnt(0)
    s_setprio 3
    s_barrier
    ds_read_b64_tr_b16 v[48:49], v12 offset:9472
    ds_read_b64_tr_b16 v[50:51], v12 offset:1152
    s_add_u32 s38, s26, 0x380000
    s_addc_u32 s39, s27, 0
    s_waitcnt lgkmcnt(0)
    global_store_dwordx4 v13, v[48:51], s[38:39]
    s_endpgm
    .p2align 12
LYSA:
    s_add_u32 s50, s50, 0x9e3779b1
    s_waitcnt vmcnt(3)
    s_xor_b32 s5, s99, 0
    s_lshl_b32 s5, s5, 8
    s_add_u32 m0, s5, 512
    v_perm_b32 v216, v124, v120, s40
    v_perm_b32 v217, v124, v120, s41
    v_perm_b32 v218, v125, v121, s40
    v_perm_b32 v219, v125, v121, s41
    ds_write_addtid_b32 v216 offset:0
    ds_write_addtid_b32 v217 offset:4608
    ds_write_addtid_b32 v218 offset:9216
    ds_write_addtid_b32 v219 offset:13824
    v_perm_b32 v216, v126, v122, s40
    v_perm_b32 v217, v126, v122, s41
    v_perm_b32 v218, v127, v123, s40
    v_perm_b32 v219, v127, v123, s41
    ds_write_addtid_b32 v216 offset:18432
    ds_write_addtid_b32 v217 offset:23040
    ds_write_addtid_b32 v218 offset:27648
    ds_write_addtid_b32 v219 offset:32256
    s_waitcnt vmcnt(1)
    s_cmp_ge_u32 s99, 2
    s_cbranch_scc1 LYA
    s_xor_b32 s5, s99, 4
    s_lshl_b32 s5, s5, 8
    s_add_u32 m0, s5, 512
    v_perm_b32 v216, v132, v128, s40
    v_perm_b32 v217, v132, v128, s41
    v_perm_b32 v218, v133, v129, s40
    v_perm_b32 v219, v133, v129, s41
    ds_write_addtid_b32 v216 offset:0
    ds_write_addtid_b32 v217 offset:4608
    ds_write_addtid_b32 v218 offset:9216
    ds_write_addtid_b32 v219 offset:13824
    v_perm_b32 v216, v134, v130, s40
    v_perm_b32 v217, v134, v130, s41
    v_perm_b32 v218, v135, v131, s40
    v_perm_b32 v219, v135, v131, s41
    ds_write_addtid_b32 v216 offset:18432
    ds_write_addtid_b32 v217 offset:23040
    ds_write_addtid_b32 v218 offset:27648
    ds_write_addtid_b32 v219 offset:32256
    s_branch LYA
    .p2align 3
LXA:
    s_mov_b32 m0, s29
    v_mov_b32_dpp v160, v45 wave_shr:1 row_mask:0xf bank_mask:0xf bound_ctrl:0
    v_mov_b32_dpp v164, v45 row_newbcast:15 row_mask:0xf bank_mask:0xf
    v_readlane_b32 s36, v46, 63
    v_alignbit_b32 v161, v48, v44, 16
    v_alignbit_b32 v162, v44, v49, 16
    v_alignbit_b32 v163, v49, v45, 16
    v_alignbit_b32 v160, v160, v48, 16
    ds_write_addtid_b32 v46 offset:2888
    ds_write_addtid_b32 v46 offset:3264
    ds_write_b16 v7, v47 offset:3648
    ds_write_b16_d16_hi v7, v47 offset:3776
    ds_write_addtid_b32 v160 offset:552
    ds_write_addtid_b32 v48 offset:824
    ds_write_addtid_b32 v161 offset:1096
    ds_write_addtid_b32 v44 offset:1368
    ds_write_addtid_b32 v162 offset:1640
    ds_write_addtid_b32 v49 offset:1912
    ds_write_addtid_b32 v163 offset:2184
    ds_write_addtid_b32 v45 offset:2456
    ds_write_addtid_b32 v163 offset:12
    ds_write_addtid_b32 v45 offset:284
    s_mov_b32 exec_lo, 0
    s_mov_b32 exec_hi, 0xbf0000
    ds_write_b16 v9, v164 offset:808
    s_mov_b64 exec, -1
    s_lshr_b32 s36, s36, 16
    v_mul_u32_u24 v16, s36, v16
    v_mul_u32_u24 v17, s36, v17
    v_mul_u32_u24 v18, s36, v18
    v_mul_u32_u24 v19, s36, v19
    s_barrier
    ds_read_b128 v[240:243], v10 offset:480
    ds_read_b128 v[244:247], v10 offset:464
    ds_read_b128 v[248:251], v10 offset:992
    ds_read2_b32 v[116:117], v4 offset0:200 offset1:64
    ds_read2_b32 v[118:119], v5 offset0:200 offset1:64
    ds_read_b128 v[252:255], v10 offset:480
    ds_read2_b32 v[52:53], v4 offset0:136 offset1:0
    ds_read2_b32 v[54:55], v5 offset0:136 offset1:0
    ds_read2_b32 v[84:85], v4 offset0:168 offset1:32
    ds_read2_b32 v[86:87], v5 offset0:168 offset1:32
    ds_read_b128 v[152:155], v10 offset:976
    ds_read2_b32 v[56:57], v4 offset0:140 offset1:4
    ds_read2_b32 v[58:59], v5 offset0:140 offset1:4
    ds_read_b128 v[156:159], v10 offset:416
    ds_read2_b32 v[88:89], v4 offset0:172 offset1:36
    ds_read2_b32 v[90:91], v5 offset0:172 offset1:36
    ds_read2_b32 v[60:61], v4 offset0:144 offset1:8
    ds_read2_b32 v[62:63], v5 offset0:144 offset1:8
    ds_read_b128 v[188:191], v10 offset:352
    ds_read2_b32 v[92:93], v4 offset0:176 offset1:40
    v_mfma_f32_16x16x32_bf16 v[216:219], v[240:243], v[20:23], 0
    ds_read2_b32 v[94:95], v5 offset0:176 offset1:40
    v_mfma_f32_16x16x32_bf16 v[220:223], v[240:243], v[24:27], 0
    ds_read2_b32 v[64:65], v4 offset0:148 offset1:12
    v_mfma_f32_16x16x32_bf16 v[224:227], v[240:243], v[28:31], 0
    ds_read2_b32 v[66:67], v5 offset0:148 offset1:12
    v_mfma_f32_16x16x32_bf16 v[228:231], v[244:247], v[32:35], 0
    ds_read2_b32 v[96:97], v4 offset0:180 offset1:44
    v_mfma_f32_16x16x32_bf16 v[232:235], v[240:243], v[36:39], 0
    ds_read_b128 v[36:39], v10 offset:1504
    s_nop 0
    v_cvt_pk_bf16_f32 v122, v216, v220
    v_cvt_pk_bf16_f32 v120, v217, v221
    v_mfma_f32_16x16x32_bf16 v[236:239], v[244:247], v[40:43], 0
    ds_read_b128 v[244:247], v10 offset:288
    v_cvt_pk_bf16_f32 v126, v218, v222
    v_cvt_pk_bf16_f32 v124, v219, v223
    v_mfma_f32_16x16x32_bf16 v[148:151], v[16:19], v[240:243], 0
    ds_read2_b32 v[98:99], v5 offset0:180 offset1:44
    v_cvt_pk_bf16_f32 v123, v224, v228
    v_cvt_pk_bf16_f32 v121, v225, v229
    v_mfma_f32_16x16x32_bf16 v[216:219], v[248:251], v[20:23], 0
    ds_read_b128 v[40:43], v10 offset:1488
    v_cvt_pk_bf16_f32 v127, v226, v230
    v_cvt_pk_bf16_f32 v125, v227, v231
    v_mfma_f32_16x16x32_bf16 v[220:223], v[248:251], v[24:27], 0
    ds_read2_b32 v[68:69], v4 offset0:152 offset1:16
    v_cvt_pk_bf16_f32 v144, v232, v236
    v_mfma_f32_16x16x32_bf16 v[208:211], v[116:119], v[252:255], 0
    ds_read2_b32 v[70:71], v5 offset0:152 offset1:16
    v_cvt_pk_bf16_f32 v145, v233, v237
    v_cvt_pk_bf16_f32 v146, v234, v238
    v_mfma_f32_16x16x32_bf16 v[200:203], v[52:55], v[252:255], 0
    ds_read_b128 v[240:243], v10 offset:224
    v_cvt_pk_bf16_f32 v147, v235, v239
    v_mfma_f32_16x16x32_bf16 v[204:207], v[84:87], v[252:255], 0
    ds_read2_b32 v[100:101], v4 offset0:184 offset1:48
    v_cvt_pk_bf16_f32 v130, v216, v220
    v_mfma_f32_16x16x32_bf16 v[224:227], v[248:251], v[28:31], 0
    ds_read2_b32 v[102:103], v5 offset0:184 offset1:48
    v_cvt_pk_bf16_f32 v128, v217, v221
    v_mfma_f32_16x16x32_bf16 v[228:231], v[152:155], v[32:35], 0
    ds_read2_b32 v[72:73], v4 offset0:156 offset1:20
    v_cvt_pk_bf16_f32 v134, v218, v222
    v_mfma_f32_16x16x32_bf16 v[200:203], v[56:59], v[156:159], v[200:203]
    ds_read2_b32 v[74:75], v5 offset0:156 offset1:20
    v_cvt_pk_bf16_f32 v132, v219, v223
    v_mfma_f32_16x16x32_bf16 v[204:207], v[88:91], v[156:159], v[204:207]
    ds_read_b128 v[16:19], v10 offset:160
    v_mfma_f32_16x16x32_bf16 v[200:203], v[60:63], v[188:191], v[200:203]
    ds_read2_b32 v[104:105], v4 offset0:188 offset1:52
    v_cvt_pk_bf16_f32 v131, v224, v228
    s_waitcnt lgkmcnt(12)
    v_mfma_f32_16x16x32_bf16 v[232:235], v[36:39], v[20:23], 0
    ds_read2_b32 v[106:107], v5 offset0:188 offset1:52
    v_cvt_pk_bf16_f32 v129, v225, v229
    v_mfma_f32_16x16x32_bf16 v[236:239], v[36:39], v[24:27], 0
    ds_read2_b32 v[76:77], v4 offset0:160 offset1:24
    v_cvt_pk_bf16_f32 v135, v226, v230
    v_mfma_f32_16x16x32_bf16 v[204:207], v[92:95], v[188:191], v[204:207]
    ds_read2_b32 v[78:79], v5 offset0:160 offset1:24
    v_cvt_pk_bf16_f32 v133, v227, v231
    s_waitcnt lgkmcnt(14)
    v_mfma_f32_16x16x32_bf16 v[200:203], v[64:67], v[244:247], v[200:203]
    ds_read_b128 v[252:255], v10 offset:96
    s_waitcnt lgkmcnt(14)
    v_mfma_f32_16x16x32_bf16 v[204:207], v[96:99], v[244:247], v[204:207]
    ds_read2_b32 v[108:109], v4 offset0:192 offset1:56
    v_cvt_pk_bf16_f32 v138, v232, v236
    v_mfma_f32_16x16x32_bf16 v[216:219], v[36:39], v[28:31], 0
    ds_read2_b32 v[110:111], v5 offset0:192 offset1:56
    v_cvt_pk_bf16_f32 v136, v233, v237
    s_waitcnt lgkmcnt(14)
    v_mfma_f32_16x16x32_bf16 v[220:223], v[40:43], v[32:35], 0
    ds_read2_b32 v[80:81], v4 offset0:164 offset1:28
    v_cvt_pk_bf16_f32 v142, v234, v238
    s_waitcnt lgkmcnt(13)
    v_mfma_f32_16x16x32_bf16 v[200:203], v[68:71], v[240:243], v[200:203]
    ds_read2_b32 v[82:83], v5 offset0:164 offset1:28
    v_cvt_pk_bf16_f32 v140, v235, v239
    s_waitcnt lgkmcnt(12)
    v_mfma_f32_16x16x32_bf16 v[204:207], v[100:103], v[240:243], v[204:207]
    ds_read_b128 v[248:251], v10 offset:32
    s_waitcnt lgkmcnt(10)
    v_mfma_f32_16x16x32_bf16 v[200:203], v[72:75], v[16:19], v[200:203]
    ds_read2_b32 v[112:113], v4 offset0:196 offset1:60
    v_cvt_pk_bf16_f32 v139, v216, v220
    s_waitcnt lgkmcnt(9)
    v_mfma_f32_16x16x32_bf16 v[204:207], v[104:107], v[16:19], v[204:207]
    ds_read2_b32 v[114:115], v5 offset0:196 offset1:60
    v_cvt_pk_bf16_f32 v137, v217, v221
    s_waitcnt lgkmcnt(7)
    v_mfma_f32_16x16x32_bf16 v[200:203], v[76:79], v[252:255], v[200:203]
    ds_read_b128 v[152:155], v10 offset:992
    v_cvt_pk_bf16_f32 v143, v218, v222
    s_waitcnt lgkmcnt(6)
    v_mfma_f32_16x16x32_bf16 v[204:207], v[108:111], v[252:255], v[204:207]
    ds_read_b128 v[156:159], v10 offset:928
    v_cvt_pk_bf16_f32 v141, v219, v223
    s_waitcnt lgkmcnt(4)
    v_mfma_f32_16x16x32_bf16 v[200:203], v[80:83], v[248:251], v[200:203]
    ds_read_b128 v[20:23], v10 offset:864
    s_waitcnt lgkmcnt(3)
    v_mfma_f32_16x16x32_bf16 v[204:207], v[112:115], v[248:251], v[204:207]
    ds_read_b128 v[24:27], v10 offset:800
    s_waitcnt lgkmcnt(3)
    v_mfma_f32_16x16x32_bf16 v[204:207], v[52:55], v[152:155], v[204:207]
    ds_read_b128 v[188:191], v10 offset:736
    s_waitcnt lgkmcnt(3)
    v_mfma_f32_16x16x32_bf16 v[204:207], v[56:59], v[156:159], v[204:207]
    ds_read_b128 v[244:247], v10 offset:672
    s_waitcnt lgkmcnt(3)
    v_mfma_f32_16x16x32_bf16 v[204:207], v[60:63], v[20:23], v[204:207]
    ds_read_b128 v[28:31], v10 offset:608
    s_waitcnt lgkmcnt(3)
    v_mfma_f32_16x16x32_bf16 v[204:207], v[64:67], v[24:27], v[204:207]
    ds_read_b128 v[36:39], v10 offset:544
    v_cvt_pk_bf16_f32 v44, v200, v201
    v_cvt_pk_bf16_f32 v45, v202, v203
    s_waitcnt lgkmcnt(3)
    v_mfma_f32_16x16x32_bf16 v[204:207], v[68:71], v[188:191], v[204:207]
    ds_write_b64 v11, v[44:45] offset:4352
    s_waitcnt lgkmcnt(3)
    v_mfma_f32_16x16x32_bf16 v[204:207], v[72:75], v[244:247], v[204:207]
    ds_read_b128 v[160:163], v6 offset:2784
    s_waitcnt lgkmcnt(3)
    v_mfma_f32_16x16x32_bf16 v[204:207], v[76:79], v[28:31], v[204:207]
    ds_read_b128 v[164:167], v6 offset:2768
    s_waitcnt lgkmcnt(3)
    v_mfma_f32_16x16x32_bf16 v[204:207], v[80:83], v[36:39], v[204:207]
    ds_read_b128 v[32:35], v10 offset:1504
    v_mfma_f32_16x16x32_bf16 v[212:215], v[116:119], v[152:155], 0
    ds_read_b128 v[40:43], v10 offset:1440
    v_mfma_f32_16x16x32_bf16 v[208:211], v[84:87], v[152:155], v[208:211]
    ds_read_b128 v[240:243], v10 offset:1376
    v_mfma_f32_16x16x32_bf16 v[208:211], v[88:91], v[156:159], v[208:211]
    ds_read_b128 v[16:19], v10 offset:1312
    v_mfma_f32_16x16x32_bf16 v[208:211], v[92:95], v[20:23], v[208:211]
    ds_read_b128 v[252:255], v10 offset:1248
    v_cvt_pk_bf16_f32 v44, v204, v205
    v_cvt_pk_bf16_f32 v45, v206, v207
    v_mfma_f32_16x16x32_bf16 v[208:211], v[96:99], v[24:27], v[208:211]
    ds_write_b64 v11, v[44:45] offset:4928
    v_mfma_f32_16x16x32_bf16 v[208:211], v[100:103], v[188:191], v[208:211]
    ds_read_b128 v[248:251], v10 offset:1184
    v_mfma_f32_16x16x32_bf16 v[208:211], v[104:107], v[244:247], v[208:211]
    ds_read_b128 v[152:155], v10 offset:1120
    v_mfma_f32_16x16x32_bf16 v[208:211], v[108:111], v[28:31], v[208:211]
    ds_read_b128 v[156:159], v10 offset:1056
    v_mfma_f32_16x16x32_bf16 v[208:211], v[112:115], v[36:39], v[208:211]
    ds_read_b128 v[168:171], v6 offset:2912
    s_waitcnt lgkmcnt(11)
    v_mfma_f32_16x16x32_bf16 v[208:211], v[120:123], v[160:163], v[208:211]
    ds_read_b128 v[172:175], v6 offset:2896
    s_waitcnt lgkmcnt(11)
    v_mfma_f32_16x16x32_bf16 v[208:211], v[124:127], v[164:167], v[208:211]
    ds_read_b128 v[176:179], v6 offset:3040
    s_waitcnt lgkmcnt(11)
    v_mfma_f32_16x16x32_bf16 v[208:211], v[52:55], v[32:35], v[208:211]
    ds_read_b128 v[180:183], v6 offset:3024
    s_waitcnt lgkmcnt(11)
    v_mfma_f32_16x16x32_bf16 v[208:211], v[56:59], v[40:43], v[208:211]
    ds_read2_b32 v[184:185], v8 offset0:3 offset1:2
    s_waitcnt lgkmcnt(11)
    v_mfma_f32_16x16x32_bf16 v[208:211], v[60:63], v[240:243], v[208:211]
    ds_read2_b32 v[186:187], v8 offset0:1 offset1:0
    s_waitcnt lgkmcnt(11)
    v_mfma_f32_16x16x32_bf16 v[208:211], v[64:67], v[16:19], v[208:211]
    s_waitcnt lgkmcnt(10)
    v_mfma_f32_16x16x32_bf16 v[208:211], v[68:71], v[252:255], v[208:211]
    s_waitcnt lgkmcnt(8)
    v_mfma_f32_16x16x32_bf16 v[208:211], v[72:75], v[248:251], v[208:211]
    s_waitcnt lgkmcnt(7)
    v_mfma_f32_16x16x32_bf16 v[208:211], v[76:79], v[152:155], v[208:211]
    s_waitcnt lgkmcnt(6)
    v_mfma_f32_16x16x32_bf16 v[208:211], v[80:83], v[156:159], v[208:211]
    v_mfma_f32_16x16x32_bf16 v[148:151], v[116:119], v[32:35], v[148:151]
    v_mfma_f32_16x16x32_bf16 v[212:215], v[84:87], v[32:35], v[212:215]
    v_mfma_f32_16x16x32_bf16 v[212:215], v[88:91], v[40:43], v[212:215]
    v_mfma_f32_16x16x32_bf16 v[212:215], v[92:95], v[240:243], v[212:215]
    s_nop 3
    v_cvt_pk_bf16_f32 v44, v208, v209
    v_cvt_pk_bf16_f32 v45, v210, v211
    v_mfma_f32_16x16x32_bf16 v[212:215], v[96:99], v[16:19], v[212:215]
    ds_write_b64 v11, v[44:45] offset:5504
    v_mfma_f32_16x16x32_bf16 v[212:215], v[100:103], v[252:255], v[212:215]
    v_mfma_f32_16x16x32_bf16 v[212:215], v[104:107], v[248:251], v[212:215]
    s_setprio 3
    s_barrier
    ds_read_b64_tr_b16 v[48:49], v12 offset:0
    ds_read_b64_tr_b16 v[50:51], v12 offset:8320
    s_add_u32 s38, s26, 0x0
    s_addc_u32 s39, s27, 0
    s_waitcnt lgkmcnt(0)
    global_store_dwordx4 v13, v[48:51], s[38:39]
    s_setprio 1
    v_mfma_f32_16x16x32_bf16 v[212:215], v[108:111], v[152:155], v[212:215]
    ds_read_b128 v[20:23], v10 offset:2016
    v_mfma_f32_16x16x32_bf16 v[212:215], v[112:115], v[156:159], v[212:215]
    ds_read_b128 v[24:27], v10 offset:1952
    v_mfma_f32_16x16x32_bf16 v[212:215], v[128:131], v[160:163], v[212:215]
    ds_read_b128 v[188:191], v10 offset:1888
    v_mfma_f32_16x16x32_bf16 v[212:215], v[132:135], v[164:167], v[212:215]
    ds_read_b128 v[244:247], v10 offset:1824
    v_mfma_f32_16x16x32_bf16 v[212:215], v[120:123], v[168:171], v[212:215]
    ds_read_b128 v[28:31], v10 offset:1760
    v_mfma_f32_16x16x32_bf16 v[212:215], v[124:127], v[172:175], v[212:215]
    ds_read_b128 v[36:39], v10 offset:1696
    v_mfma_f32_16x16x32_bf16 v[148:151], v[136:139], v[160:163], v[148:151]
    ds_read_b128 v[32:35], v10 offset:1632
    v_mfma_f32_16x16x32_bf16 v[148:151], v[140:143], v[164:167], v[148:151]
    s_setprio 3
    s_barrier
    ds_read_b64_tr_b16 v[48:49], v12 offset:576
    ds_read_b64_tr_b16 v[50:51], v12 offset:8896
    s_add_u32 s38, s26, 0x80000
    s_addc_u32 s39, s27, 0
    s_waitcnt lgkmcnt(0)
    global_store_dwordx4 v13, v[48:51], s[38:39]
    s_setprio 1
    v_mfma_f32_16x16x32_bf16 v[148:151], v[128:131], v[168:171], v[148:151]
    ds_read_b128 v[40:43], v10 offset:1568
    v_mfma_f32_16x16x32_bf16 v[148:151], v[132:135], v[172:175], v[148:151]
    v_mfma_f32_16x16x32_bf16 v[212:215], v[52:55], v[20:23], v[212:215]
    v_mfma_f32_16x16x32_bf16 v[212:215], v[56:59], v[24:27], v[212:215]
    v_mfma_f32_16x16x32_bf16 v[212:215], v[60:63], v[188:191], v[212:215]
    v_mfma_f32_16x16x32_bf16 v[212:215], v[64:67], v[244:247], v[212:215]
    v_mfma_f32_16x16x32_bf16 v[212:215], v[68:71], v[28:31], v[212:215]
    v_mfma_f32_16x16x32_bf16 v[212:215], v[72:75], v[36:39], v[212:215]
    s_setprio 3
    s_barrier
    ds_read_b64_tr_b16 v[48:49], v12 offset:1152
    ds_read_b64_tr_b16 v[50:51], v12 offset:9472
    s_add_u32 s38, s26, 0x100000
    s_addc_u32 s39, s27, 0
    s_waitcnt lgkmcnt(0)
    global_store_dwordx4 v13, v[48:51], s[38:39]
    s_setprio 1
    v_mfma_f32_16x16x32_bf16 v[212:215], v[76:79], v[32:35], v[212:215]
    ds_read_b128 v[240:243], v10 offset:2528
    v_mfma_f32_16x16x32_bf16 v[212:215], v[80:83], v[40:43], v[212:215]
    ds_read_b128 v[16:19], v10 offset:2464
    v_mfma_f32_16x16x32_bf16 v[148:151], v[84:87], v[20:23], v[148:151]
    ds_read_b128 v[252:255], v10 offset:2400
    v_mfma_f32_16x16x32_bf16 v[148:151], v[88:91], v[24:27], v[148:151]
    ds_read_b128 v[248:251], v10 offset:2336
    v_mfma_f32_16x16x32_bf16 v[148:151], v[92:95], v[188:191], v[148:151]
    ds_read_b128 v[152:155], v10 offset:2272
    v_mfma_f32_16x16x32_bf16 v[148:151], v[96:99], v[244:247], v[148:151]
    ds_read_b128 v[156:159], v10 offset:2208
    v_cvt_pk_bf16_f32 v44, v212, v213
    v_cvt_pk_bf16_f32 v45, v214, v215
    v_mfma_f32_16x16x32_bf16 v[148:151], v[100:103], v[28:31], v[148:151]
    ds_write_b64 v11, v[44:45] offset:6080
    v_mfma_f32_16x16x32_bf16 v[148:151], v[104:107], v[36:39], v[148:151]
    s_waitcnt lgkmcnt(0)
    s_setprio 3
    s_barrier
    ds_read_b64_tr_b16 v[48:49], v12 offset:1728
    ds_read_b64_tr_b16 v[50:51], v12 offset:10048
    s_add_u32 s38, s26, 0x180000
    s_addc_u32 s39, s27, 0
    s_waitcnt lgkmcnt(0)
    global_store_dwordx4 v13, v[48:51], s[38:39]
    s_setprio 1
    v_mfma_f32_16x16x32_bf16 v[148:151], v[108:111], v[32:35], v[148:151]
    ds_read_b128 v[20:23], v10 offset:2144
    v_mfma_f32_16x16x32_bf16 v[148:151], v[112:115], v[40:43], v[148:151]
    ds_read_b128 v[24:27], v10 offset:2080
    v_mfma_f32_16x16x32_bf16 v[148:151], v[120:123], v[176:179], v[148:151]
    v_mfma_f32_16x16x32_bf16 v[148:151], v[124:127], v[180:183], v[148:151]
    v_mfma_f32_16x16x32_bf16 v[148:151], v[144:147], v[184:187], v[148:151]
    v_mfma_f32_16x16x32_bf16 v[148:151], v[52:55], v[240:243], v[148:151]
    v_mfma_f32_16x16x32_bf16 v[148:151], v[56:59], v[16:19], v[148:151]
    v_mfma_f32_16x16x32_bf16 v[148:151], v[60:63], v[252:255], v[148:151]
    v_mfma_f32_16x16x32_bf16 v[148:151], v[64:67], v[248:251], v[148:151]
    v_mfma_f32_16x16x32_bf16 v[148:151], v[68:71], v[152:155], v[148:151]
    v_mfma_f32_16x16x32_bf16 v[148:151], v[72:75], v[156:159], v[148:151]
    s_waitcnt lgkmcnt(1)
    v_mfma_f32_16x16x32_bf16 v[148:151], v[76:79], v[20:23], v[148:151]
    s_waitcnt lgkmcnt(0)
    v_mfma_f32_16x16x32_bf16 v[148:151], v[80:83], v[24:27], v[148:151]
    s_nop 7
    v_cvt_pk_bf16_f32 v44, v148, v149
    v_cvt_pk_bf16_f32 v45, v150, v151
    ds_write_b64 v11, v[44:45] offset:6656
    s_waitcnt lgkmcnt(0)
    s_setprio 3
    s_barrier
    ds_read_b64_tr_b16 v[48:49], v12 offset:2304
    ds_read_b64_tr_b16 v[50:51], v12 offset:10624
    s_add_u32 s38, s26, 0x200000
    s_addc_u32 s39, s27, 0
    s_waitcnt lgkmcnt(0)
    global_store_dwordx4 v13, v[48:51], s[38:39]
    s_endpgm
    .p2align 12
LYB:
    v_bfi_b32 v16, v36, 0, v20
    v_bfi_b32 v17, v37, 0, v21
    v_bfi_b32 v18, v38, 0, v22
    v_bfi_b32 v19, v39, 0, v23
    s_waitcnt lgkmcnt(0)
    s_barrier
    s_setprio 2
    ds_read_b128 v[92:95], v10 offset:480
    ds_read_b128 v[96:99], v10 offset:464
    ds_read_b128 v[100:103], v10 offset:992
    ds_read_b128 v[104:107], v10 offset:976
    ds_read_b128 v[240:243], v10 offset:1504
    ds_read_b128 v[244:247], v10 offset:1488
    ds_read_b128 v[248:251], v10 offset:2016
    ds_read_b128 v[252:255], v10 offset:2000
    ds_write_b64 v62, v[74:75]
    ds_write_b64 v64, v[74:75] offset:2768
    s_add_u32 s5, s31, 8
    s_lshl_b32 s5, s5, 17
    s_add_u32 s38, s8, s5
    s_addc_u32 s39, s9, 0
    global_load_dwordx4 v[192:195], v15, s[38:39]
    global_load_dwordx4 v[196:199], v1, s[38:39]
    s_waitcnt lgkmcnt(9)
    v_mfma_f32_16x16x32_bf16 v[216:219], v[92:95], v[36:39], 0
    s_waitcnt lgkmcnt(8)
    v_mfma_f32_16x16x32_bf16 v[220:223], v[96:99], v[40:43], 0
    s_waitcnt lgkmcnt(7)
    v_mfma_f32_16x16x32_bf16 v[200:203], v[16:19], v[100:103], 0
    v_mfma_f32_16x16x32_bf16 v[224:227], v[100:103], v[20:23], 0
    v_mfma_f32_16x16x32_bf16 v[228:231], v[100:103], v[24:27], 0
    s_nop 3
    v_cvt_pk_bf16_f32 v144, v216, v220
    v_cvt_pk_bf16_f32 v145, v217, v221
    v_mfma_f32_16x16x32_bf16 v[232:235], v[100:103], v[28:31], 0
    v_cvt_pk_bf16_f32 v146, v218, v222
    v_cvt_pk_bf16_f32 v147, v219, v223
    s_waitcnt lgkmcnt(6)
    v_mfma_f32_16x16x32_bf16 v[236:239], v[104:107], v[32:35], 0
    v_mfma_f32_16x16x32_bf16 v[216:219], v[100:103], v[36:39], 0
    v_cvt_pk_bf16_f32 v122, v224, v228
    v_cvt_pk_bf16_f32 v120, v225, v229
    v_mfma_f32_16x16x32_bf16 v[220:223], v[104:107], v[40:43], 0
    v_cvt_pk_bf16_f32 v126, v226, v230
    v_cvt_pk_bf16_f32 v124, v227, v231
    s_waitcnt lgkmcnt(5)
    v_mfma_f32_16x16x32_bf16 v[204:207], v[16:19], v[240:243], 0
    v_cvt_pk_bf16_f32 v123, v232, v236
    v_cvt_pk_bf16_f32 v121, v233, v237
    v_mfma_f32_16x16x32_bf16 v[224:227], v[240:243], v[20:23], 0
    v_cvt_pk_bf16_f32 v127, v234, v238
    v_cvt_pk_bf16_f32 v125, v235, v239
    v_mfma_f32_16x16x32_bf16 v[228:231], v[240:243], v[24:27], 0
    v_cvt_pk_bf16_f32 v148, v216, v220
    v_cvt_pk_bf16_f32 v149, v217, v221
    v_mfma_f32_16x16x32_bf16 v[232:235], v[240:243], v[28:31], 0
    v_cvt_pk_bf16_f32 v150, v218, v222
    v_cvt_pk_bf16_f32 v151, v219, v223
    s_waitcnt lgkmcnt(4)
    v_mfma_f32_16x16x32_bf16 v[236:239], v[244:247], v[32:35], 0
    v_mfma_f32_16x16x32_bf16 v[216:219], v[240:243], v[36:39], 0
    v_cvt_pk_bf16_f32 v130, v224, v228
    v_cvt_pk_bf16_f32 v128, v225, v229
    v_mfma_f32_16x16x32_bf16 v[220:223], v[244:247], v[40:43], 0
    v_cvt_pk_bf16_f32 v134, v226, v230
    v_cvt_pk_bf16_f32 v132, v227, v231
    s_waitcnt lgkmcnt(3)
    v_mfma_f32_16x16x32_bf16 v[208:211], v[16:19], v[248:251], 0
    v_cvt_pk_bf16_f32 v131, v232, v236
    v_cvt_pk_bf16_f32 v129, v233, v237
    v_mfma_f32_16x16x32_bf16 v[224:227], v[248:251], v[20:23], 0
    v_cvt_pk_bf16_f32 v135, v234, v238
    v_cvt_pk_bf16_f32 v133, v235, v239
    v_mfma_f32_16x16x32_bf16 v[228:231], v[248:251], v[24:27], 0
    v_cvt_pk_bf16_f32 v152, v216, v220
    v_cvt_pk_bf16_f32 v153, v217, v221
    v_mfma_f32_16x16x32_bf16 v[232:235], v[248:251], v[28:31], 0
    v_cvt_pk_bf16_f32 v154, v218, v222
    v_cvt_pk_bf16_f32 v155, v219, v223
    s_waitcnt lgkmcnt(2)
    v_mfma_f32_16x16x32_bf16 v[236:239], v[252:255], v[32:35], 0
    v_mfma_f32_16x16x32_bf16 v[216:219], v[248:251], v[36:39], 0
    v_cvt_pk_bf16_f32 v138, v224, v228
    v_cvt_pk_bf16_f32 v136, v225, v229
    v_mfma_f32_16x16x32_bf16 v[220:223], v[252:255], v[40:43], 0
    v_cvt_pk_bf16_f32 v142, v226, v230
    v_cvt_pk_bf16_f32 v140, v227, v231
    s_nop 1
    v_cvt_pk_bf16_f32 v139, v232, v236
    v_cvt_pk_bf16_f32 v137, v233, v237
    v_cvt_pk_bf16_f32 v143, v234, v238
    v_cvt_pk_bf16_f32 v141, v235, v239
    v_cvt_pk_bf16_f32 v156, v216, v220
    v_cvt_pk_bf16_f32 v157, v217, v221
    v_cvt_pk_bf16_f32 v158, v218, v222
    v_cvt_pk_bf16_f32 v159, v219, v223
    global_load_dwordx4 v[44:47], v14, s[48:49] offset:0 sc1
    global_load_dwordx4 v[48:51], v3, s[48:49] offset:1024 sc1
    s_waitcnt vmcnt(2)
    s_add_u32 s5, s31, 8
    s_lshl_b32 s5, s5, 8
    s_add_u32 m0, s5, 512
    v_perm_b32 v216, v196, v192, s40
    v_perm_b32 v217, v196, v192, s41
    v_perm_b32 v218, v197, v193, s40
    v_perm_b32 v219, v197, v193, s41
    ds_write_addtid_b32 v216 offset:0
    ds_write_addtid_b32 v217 offset:4608
    ds_write_addtid_b32 v218 offset:9216
    ds_write_addtid_b32 v219 offset:13824
    v_perm_b32 v216, v198, v194, s40
    v_perm_b32 v217, v198, v194, s41
    v_perm_b32 v218, v199, v195, s40
    v_perm_b32 v219, v199, v195, s41
    ds_write_addtid_b32 v216 offset:18432
    ds_write_addtid_b32 v217 offset:23040
    ds_write_addtid_b32 v218 offset:27648
    ds_write_addtid_b32 v219 offset:32256
    s_waitcnt lgkmcnt(0)
    s_barrier
    ds_read_b128 v[240:243], v10 offset:2528
    ds_read_b128 v[244:247], v10 offset:2512
    ds_read_b128 v[252:255], v10 offset:3040
    s_waitcnt lgkmcnt(2)
    v_mfma_f32_16x16x32_bf16 v[216:219], v[240:243], v[20:23], 0
    v_mfma_f32_16x16x32_bf16 v[220:223], v[240:243], v[24:27], 0
    v_mfma_f32_16x16x32_bf16 v[224:227], v[240:243], v[28:31], 0
    s_waitcnt lgkmcnt(1)
    v_mfma_f32_16x16x32_bf16 v[228:231], v[244:247], v[32:35], 0
    ds_read_b128 v[244:247], v10 offset:3024
    s_nop 3
    v_cvt_pk_bf16_f32 v38, v216, v220
    v_cvt_pk_bf16_f32 v36, v217, v221
    v_cvt_pk_bf16_f32 v42, v218, v222
    v_cvt_pk_bf16_f32 v40, v219, v223
    s_waitcnt lgkmcnt(1)
    v_mfma_f32_16x16x32_bf16 v[216:219], v[252:255], v[20:23], 0
    ds_read_b128 v[20:23], v10 offset:2464
    v_mfma_f32_16x16x32_bf16 v[220:223], v[252:255], v[24:27], 0
    ds_read_b128 v[24:27], v10 offset:2400
    v_cvt_pk_bf16_f32 v39, v224, v228
    v_cvt_pk_bf16_f32 v37, v225, v229
    v_cvt_pk_bf16_f32 v43, v226, v230
    v_cvt_pk_bf16_f32 v41, v227, v231
    v_mfma_f32_16x16x32_bf16 v[224:227], v[252:255], v[28:31], 0
    ds_read_b128 v[252:255], v10 offset:2336
    s_waitcnt lgkmcnt(3)
    v_mfma_f32_16x16x32_bf16 v[228:231], v[244:247], v[32:35], 0
    ds_read_b128 v[28:31], v10 offset:2272
    ds_read_b128 v[244:247], v10 offset:2208
    ds_read_b128 v[32:35], v10 offset:2144
    v_cvt_pk_bf16_f32 v18, v216, v220
    v_cvt_pk_bf16_f32 v16, v217, v221
    v_cvt_pk_bf16_f32 v234, v218, v222
    v_cvt_pk_bf16_f32 v232, v219, v223
    s_nop 0
    v_cvt_pk_bf16_f32 v19, v224, v228
    v_cvt_pk_bf16_f32 v17, v225, v229
    v_cvt_pk_bf16_f32 v235, v226, v230
    v_cvt_pk_bf16_f32 v233, v227, v231
    s_waitcnt vmcnt(0)
LchkB:
    v_add3_u32 v218, v44, v45, v46
    v_lshl_add_u32 v216, v47, 1, v218
    v_lshl_add_u32 v217, v47, 1, v218
    v_add3_u32 v218, v48, v49, v50
    v_sub_u32 v218, v51, v218
    v_permlane32_swap_b32 v216, v217
    v_add3_u32 v216, v216, v217, s50
    v_cmp_ne_u32 vcc, v216, v218
    s_mov_b32 exec_lo, 0
    v_mov_b32 v48, v50
    v_perm_b32 v49, v44, v44, s40
    s_mov_b32 exec_lo, -1
    s_cmp_eq_u64 vcc, 0
    s_cbranch_scc1 LgotB
    global_load_dwordx4 v[44:47], v14, s[48:49] offset:0 sc1
    global_load_dwordx4 v[48:51], v3, s[48:49] offset:1024 sc1
    s_add_u32 s51, s51, 1
    s_cmp_ge_u32 s51, 0x40000
    s_waitcnt vmcnt(0)
    s_cbranch_scc0 LchkB
LgotB:
    s_mov_b32 m0, s29
    v_mov_b32_dpp v160, v45 wave_shr:1 row_mask:0xf bank_mask:0xf bound_ctrl:0
    v_mov_b32_dpp v164, v45 row_newbcast:15 row_mask:0xf bank_mask:0xf
    v_readlane_b32 s36, v46, 63
    v_alignbit_b32 v161, v48, v44, 16
    v_alignbit_b32 v162, v44, v49, 16
    v_alignbit_b32 v163, v49, v45, 16
    v_alignbit_b32 v160, v160, v48, 16
    ds_write_addtid_b32 v46 offset:2888
    ds_write_addtid_b32 v46 offset:3264
    ds_write_b16 v7, v47 offset:3648
    ds_write_b16_d16_hi v7, v47 offset:3776
    ds_write_addtid_b32 v160 offset:552
    ds_write_addtid_b32 v48 offset:824
    ds_write_addtid_b32 v161 offset:1096
    ds_write_addtid_b32 v44 offset:1368
    ds_write_addtid_b32 v162 offset:1640
    ds_write_addtid_b32 v49 offset:1912
    ds_write_addtid_b32 v163 offset:2184
    ds_write_addtid_b32 v45 offset:2456
    ds_write_addtid_b32 v163 offset:12
    ds_write_addtid_b32 v45 offset:284
    s_mov_b32 exec_lo, 0
    s_mov_b32 exec_hi, 0xbf0000
    ds_write_b16 v9, v164 offset:808
    s_mov_b64 exec, -1
    ds_read_b128 v[176:179], v6 offset:3040
    ds_read_b128 v[180:183], v6 offset:3024
    ds_read_b128 v[168:171], v6 offset:2912
    ds_read_b128 v[172:175], v6 offset:2896
    ds_read_b128 v[160:163], v6 offset:2784
    ds_read_b128 v[164:167], v6 offset:2768
    ds_read2_b32 v[184:185], v8 offset0:3 offset1:2
    ds_read2_b32 v[186:187], v8 offset0:1 offset1:0
    ds_read2_b32 v[188:189], v8 offset0:19 offset1:18
    ds_read2_b32 v[190:191], v8 offset0:17 offset1:16
    ds_read2_b32 v[116:117], v4 offset0:200 offset1:64
    ds_read2_b32 v[118:119], v5 offset0:200 offset1:64
    ds_read2_b32 v[84:85], v4 offset0:168 offset1:32
    ds_read2_b32 v[86:87], v5 offset0:168 offset1:32
    s_add_u32 s5, s31, 12
    s_lshl_b32 s5, s5, 17
    s_add_u32 s38, s8, s5
    s_addc_u32 s39, s9, 0
    global_load_dwordx4 v[212:215], v15, s[38:39]
    global_load_dwordx4 v[236:239], v1, s[38:39]
    s_and_b32 s36, s36, 0xffff0000
    v_mul_f32 v200, s36, v200
    v_mul_f32 v201, s36, v201
    v_mul_f32 v202, s36, v202
    v_mul_f32 v203, s36, v203
    s_waitcnt lgkmcnt(13)
    s_nop 0
    v_mfma_f32_16x16x32_bf16 v[200:203], v[120:123], v[176:179], v[200:203]
    ds_read2_b32 v[88:89], v4 offset0:172 offset1:36
    v_mul_f32 v204, s36, v204
    v_mul_f32 v205, s36, v205
    s_waitcnt lgkmcnt(13)
    v_mfma_f32_16x16x32_bf16 v[200:203], v[124:127], v[180:183], v[200:203]
    ds_read2_b32 v[90:91], v5 offset0:172 offset1:36
    v_mul_f32 v206, s36, v206
    v_mul_f32 v207, s36, v207
    s_waitcnt lgkmcnt(13)
    v_mfma_f32_16x16x32_bf16 v[200:203], v[128:131], v[168:171], v[200:203]
    ds_read2_b32 v[92:93], v4 offset0:176 offset1:40
    v_mul_f32 v208, s36, v208
    s_waitcnt lgkmcnt(13)
    v_mfma_f32_16x16x32_bf16 v[200:203], v[132:135], v[172:175], v[200:203]
    ds_read2_b32 v[94:95], v5 offset0:176 offset1:40
    v_mul_f32 v209, s36, v209
    s_waitcnt lgkmcnt(13)
    v_mfma_f32_16x16x32_bf16 v[200:203], v[136:139], v[160:163], v[200:203]
    ds_read2_b32 v[96:97], v4 offset0:180 offset1:44
    v_mul_f32 v210, s36, v210
    s_waitcnt lgkmcnt(13)
    v_mfma_f32_16x16x32_bf16 v[200:203], v[140:143], v[164:167], v[200:203]
    ds_read2_b32 v[98:99], v5 offset0:180 offset1:44
    ds_read2_b32 v[100:101], v4 offset0:184 offset1:48
    v_mul_f32 v211, s36, v211
    s_waitcnt lgkmcnt(13)
    v_mfma_f32_16x16x32_bf16 v[200:203], v[148:151], v[184:187], v[200:203]
    ds_read2_b32 v[102:103], v5 offset0:184 offset1:48
    ds_read2_b32 v[104:105], v4 offset0:188 offset1:52
    s_waitcnt lgkmcnt(13)
    v_mfma_f32_16x16x32_bf16 v[200:203], v[144:147], v[188:191], v[200:203]
    ds_read2_b32 v[106:107], v5 offset0:188 offset1:52
    ds_read2_b32 v[108:109], v4 offset0:192 offset1:56
    s_waitcnt lgkmcnt(13)
    v_mfma_f32_16x16x32_bf16 v[200:203], v[116:119], v[248:251], v[200:203]
    ds_read2_b32 v[110:111], v5 offset0:192 offset1:56
    ds_read2_b32 v[112:113], v4 offset0:196 offset1:60
    v_mfma_f32_16x16x32_bf16 v[204:207], v[116:119], v[240:243], v[204:207]
    ds_read2_b32 v[114:115], v5 offset0:196 offset1:60
    ds_read_b128 v[220:223], v10 offset:2080
    s_waitcnt lgkmcnt(14)
    v_mfma_f32_16x16x32_bf16 v[200:203], v[84:87], v[240:243], v[200:203]
    ds_read2_b32 v[52:53], v4 offset0:136 offset1:0
    ds_read2_b32 v[54:55], v5 offset0:136 offset1:0
    s_waitcnt lgkmcnt(14)
    v_mfma_f32_16x16x32_bf16 v[200:203], v[88:91], v[20:23], v[200:203]
    ds_read_b128 v[224:227], v10 offset:3040
    ds_read2_b32 v[56:57], v4 offset0:140 offset1:4
    s_waitcnt lgkmcnt(14)
    v_mfma_f32_16x16x32_bf16 v[200:203], v[92:95], v[24:27], v[200:203]
    ds_read2_b32 v[58:59], v5 offset0:140 offset1:4
    ds_read_b128 v[228:231], v10 offset:2976
    s_waitcnt lgkmcnt(14)
    v_mfma_f32_16x16x32_bf16 v[200:203], v[96:99], v[252:255], v[200:203]
    ds_read2_b32 v[60:61], v4 offset0:144 offset1:8
    ds_read2_b32 v[62:63], v5 offset0:144 offset1:8
    s_waitcnt lgkmcnt(14)
    v_mfma_f32_16x16x32_bf16 v[200:203], v[100:103], v[28:31], v[200:203]
    ds_read_b128 v[248:251], v10 offset:2912
    ds_read2_b32 v[64:65], v4 offset0:148 offset1:12
    s_waitcnt lgkmcnt(14)
    v_mfma_f32_16x16x32_bf16 v[200:203], v[104:107], v[244:247], v[200:203]
    ds_read2_b32 v[66:67], v5 offset0:148 offset1:12
    ds_read_b128 v[240:243], v10 offset:2848
    s_waitcnt lgkmcnt(14)
    v_mfma_f32_16x16x32_bf16 v[200:203], v[108:111], v[32:35], v[200:203]
    ds_read2_b32 v[68:69], v4 offset0:152 offset1:16
    ds_read2_b32 v[70:71], v5 offset0:152 offset1:16
    s_waitcnt lgkmcnt(14)
    v_mfma_f32_16x16x32_bf16 v[200:203], v[112:115], v[220:223], v[200:203]
    ds_read_b128 v[20:23], v10 offset:2784
    ds_read2_b32 v[72:73], v4 offset0:156 offset1:20
    s_waitcnt lgkmcnt(13)
    v_mfma_f32_16x16x32_bf16 v[200:203], v[52:55], v[224:227], v[200:203]
    ds_read2_b32 v[74:75], v5 offset0:156 offset1:20
    ds_read_b128 v[24:27], v10 offset:2720
    s_waitcnt lgkmcnt(12)
    v_mfma_f32_16x16x32_bf16 v[200:203], v[56:59], v[228:231], v[200:203]
    ds_read2_b32 v[76:77], v4 offset0:160 offset1:24
    ds_read2_b32 v[78:79], v5 offset0:160 offset1:24
    s_waitcnt lgkmcnt(11)
    v_mfma_f32_16x16x32_bf16 v[200:203], v[60:63], v[248:251], v[200:203]
    ds_read_b128 v[252:255], v10 offset:2656
    ds_read2_b32 v[80:81], v4 offset0:164 offset1:28
    s_waitcnt lgkmcnt(10)
    v_mfma_f32_16x16x32_bf16 v[200:203], v[64:67], v[240:243], v[200:203]
    ds_read2_b32 v[82:83], v5 offset0:164 offset1:28
    ds_read_b128 v[28:31], v10 offset:2592
    s_waitcnt lgkmcnt(9)
    v_mfma_f32_16x16x32_bf16 v[200:203], v[68:71], v[20:23], v[200:203]
    ds_read2_b32 v[192:193], v8 offset0:35 offset1:34
    s_waitcnt lgkmcnt(7)
    v_mfma_f32_16x16x32_bf16 v[200:203], v[72:75], v[24:27], v[200:203]
    ds_read2_b32 v[194:195], v8 offset0:33 offset1:32
    s_waitcnt lgkmcnt(5)
    v_mfma_f32_16x16x32_bf16 v[200:203], v[76:79], v[252:255], v[200:203]
    ds_read2_b32 v[196:197], v8 offset0:51 offset1:50
    s_waitcnt lgkmcnt(3)
    v_mfma_f32_16x16x32_bf16 v[200:203], v[80:83], v[28:31], v[200:203]
    ds_read2_b32 v[198:199], v8 offset0:49 offset1:48
    s_waitcnt vmcnt(0)
    s_add_u32 s5, s31, 12
    s_lshl_b32 s5, s5, 8
    s_add_u32 m0, s5, 512
    v_perm_b32 v216, v236, v212, s40
    v_perm_b32 v217, v236, v212, s41
    v_perm_b32 v218, v237, v213, s40
    v_perm_b32 v219, v237, v213, s41
    ds_write_addtid_b32 v216 offset:0
    ds_write_addtid_b32 v217 offset:4608
    ds_write_addtid_b32 v218 offset:9216
    ds_write_addtid_b32 v219 offset:13824
    v_perm_b32 v216, v238, v214, s40
    v_perm_b32 v217, v238, v214, s41
    v_perm_b32 v218, v239, v215, s40
    v_perm_b32 v219, v239, v215, s41
    ds_write_addtid_b32 v216 offset:18432
    ds_write_addtid_b32 v217 offset:23040
    ds_write_addtid_b32 v218 offset:27648
    ds_write_addtid_b32 v219 offset:32256
    v_mfma_f32_16x16x32_bf16 v[208:211], v[116:119], v[224:227], v[208:211]
    v_mfma_f32_16x16x32_bf16 v[204:207], v[84:87], v[224:227], v[204:207]
    v_mfma_f32_16x16x32_bf16 v[204:207], v[88:91], v[228:231], v[204:207]
    v_mfma_f32_16x16x32_bf16 v[204:207], v[92:95], v[248:251], v[204:207]
    v_cvt_pk_bf16_f32 v44, v200, v201
    v_cvt_pk_bf16_f32 v45, v202, v203
    v_mfma_f32_16x16x32_bf16 v[204:207], v[96:99], v[240:243], v[204:207]
    ds_write_b64 v11, v[44:45] offset:4352
    v_mfma_f32_16x16x32_bf16 v[204:207], v[100:103], v[20:23], v[204:207]
    v_mfma_f32_16x16x32_bf16 v[204:207], v[104:107], v[24:27], v[204:207]
    v_mfma_f32_16x16x32_bf16 v[204:207], v[108:111], v[252:255], v[204:207]
    s_waitcnt lgkmcnt(0)
    s_barrier
    s_setprio 0
    v_mfma_f32_16x16x32_bf16 v[204:207], v[112:115], v[28:31], v[204:207]
    ds_read_b128 v[244:247], v10 offset:3552
    v_mfma_f32_16x16x32_bf16 v[204:207], v[128:131], v[176:179], v[204:207]
    ds_read_b128 v[32:35], v10 offset:3488
    v_mfma_f32_16x16x32_bf16 v[204:207], v[132:135], v[180:183], v[204:207]
    ds_read_b128 v[220:223], v10 offset:3424
    v_mfma_f32_16x16x32_bf16 v[204:207], v[136:139], v[168:171], v[204:207]
    ds_read_b128 v[224:227], v10 offset:3360
    v_mfma_f32_16x16x32_bf16 v[204:207], v[140:143], v[172:175], v[204:207]
    ds_read_b128 v[228:231], v10 offset:3296
    v_mfma_f32_16x16x32_bf16 v[204:207], v[36:39], v[160:163], v[204:207]
    ds_read_b128 v[248:251], v10 offset:3232
    v_mfma_f32_16x16x32_bf16 v[204:207], v[40:43], v[164:167], v[204:207]
    ds_read_b128 v[240:243], v10 offset:3168
    v_mfma_f32_16x16x32_bf16 v[204:207], v[152:155], v[184:187], v[204:207]
    ds_read_b128 v[20:23], v10 offset:3104
    v_mfma_f32_16x16x32_bf16 v[204:207], v[148:151], v[188:191], v[204:207]
    ds_read_b128 v[24:27], v10 offset:4064
    v_mfma_f32_16x16x32_bf16 v[204:207], v[144:147], v[192:195], v[204:207]
    ds_read_b128 v[252:255], v10 offset:4000
    s_waitcnt lgkmcnt(9)
    v_mfma_f32_16x16x32_bf16 v[204:207], v[52:55], v[244:247], v[204:207]
    ds_read_b128 v[28:31], v10 offset:3936
    s_waitcnt lgkmcnt(9)
    v_mfma_f32_16x16x32_bf16 v[204:207], v[56:59], v[32:35], v[204:207]
    s_waitcnt lgkmcnt(8)
    v_mfma_f32_16x16x32_bf16 v[204:207], v[60:63], v[220:223], v[204:207]
    s_waitcnt lgkmcnt(7)
    v_mfma_f32_16x16x32_bf16 v[204:207], v[64:67], v[224:227], v[204:207]
    s_waitcnt lgkmcnt(6)
    v_mfma_f32_16x16x32_bf16 v[204:207], v[68:71], v[228:231], v[204:207]
    s_waitcnt lgkmcnt(5)
    v_mfma_f32_16x16x32_bf16 v[204:207], v[72:75], v[248:251], v[204:207]
    s_waitcnt lgkmcnt(4)
    v_mfma_f32_16x16x32_bf16 v[204:207], v[76:79], v[240:243], v[204:207]
    s_waitcnt lgkmcnt(3)
    v_mfma_f32_16x16x32_bf16 v[204:207], v[80:83], v[20:23], v[204:207]
    v_mfma_f32_16x16x32_bf16 v[208:211], v[84:87], v[244:247], v[208:211]
    ds_read_b128 v[244:247], v10 offset:3872
    v_mfma_f32_16x16x32_bf16 v[208:211], v[88:91], v[32:35], v[208:211]
    ds_read_b128 v[32:35], v10 offset:3808
    v_mfma_f32_16x16x32_bf16 v[208:211], v[92:95], v[220:223], v[208:211]
    ds_read_b128 v[220:223], v10 offset:3744
    v_mfma_f32_16x16x32_bf16 v[208:211], v[96:99], v[224:227], v[208:211]
    ds_read_b128 v[224:227], v10 offset:3680
    v_cvt_pk_bf16_f32 v44, v204, v205
    v_cvt_pk_bf16_f32 v45, v206, v207
    v_mfma_f32_16x16x32_bf16 v[208:211], v[100:103], v[228:231], v[208:211]
    ds_write_b64 v11, v[44:45] offset:4928
    v_mfma_f32_16x16x32_bf16 v[208:211], v[104:107], v[248:251], v[208:211]
    ds_read_b128 v[228:231], v10 offset:3616
    v_mfma_f32_16x16x32_bf16 v[208:211], v[108:111], v[240:243], v[208:211]
    v_mfma_f32_16x16x32_bf16 v[208:211], v[112:115], v[20:23], v[208:211]
    s_waitcnt lgkmcnt(1)
    s_barrier
    v_mfma_f32_16x16x32_bf16 v[208:211], v[136:139], v[176:179], v[208:211]
    v_mfma_f32_16x16x32_bf16 v[208:211], v[140:143], v[180:183], v[208:211]
    v_mfma_f32_16x16x32_bf16 v[208:211], v[36:39], v[168:171], v[208:211]
    v_mfma_f32_16x16x32_bf16 v[208:211], v[40:43], v[172:175], v[208:211]
    v_mfma_f32_16x16x32_bf16 v[208:211], v[16:19], v[160:163], v[208:211]
    v_mfma_f32_16x16x32_bf16 v[208:211], v[232:235], v[164:167], v[208:211]
    v_mfma_f32_16x16x32_bf16 v[208:211], v[156:159], v[184:187], v[208:211]
    v_mfma_f32_16x16x32_bf16 v[208:211], v[152:155], v[188:191], v[208:211]
    v_mfma_f32_16x16x32_bf16 v[208:211], v[148:151], v[192:195], v[208:211]
    v_mfma_f32_16x16x32_bf16 v[208:211], v[144:147], v[196:199], v[208:211]
    v_mfma_f32_16x16x32_bf16 v[208:211], v[52:55], v[24:27], v[208:211]
    v_mfma_f32_16x16x32_bf16 v[208:211], v[56:59], v[252:255], v[208:211]
    v_mfma_f32_16x16x32_bf16 v[208:211], v[60:63], v[28:31], v[208:211]
    v_mfma_f32_16x16x32_bf16 v[208:211], v[64:67], v[244:247], v[208:211]
    v_mfma_f32_16x16x32_bf16 v[208:211], v[68:71], v[32:35], v[208:211]
    v_mfma_f32_16x16x32_bf16 v[208:211], v[72:75], v[220:223], v[208:211]
    v_mfma_f32_16x16x32_bf16 v[208:211], v[76:79], v[224:227], v[208:211]
    s_waitcnt lgkmcnt(0)
    v_mfma_f32_16x16x32_bf16 v[208:211], v[80:83], v[228:231], v[208:211]
    s_nop 7
    v_cvt_pk_bf16_f32 v44, v208, v209
    v_cvt_pk_bf16_f32 v45, v210, v211
    ds_write_b64 v11, v[44:45] offset:5504
    s_waitcnt lgkmcnt(0)
    s_barrier
    s_endpgm
    .p2align 12
LYA:
    v_bfi_b32 v16, v36, 0, v20
    v_bfi_b32 v17, v37, 0, v21
    v_bfi_b32 v18, v38, 0, v22
    v_bfi_b32 v19, v39, 0, v23
    s_waitcnt lgkmcnt(0)
    s_barrier
    s_setprio 2
    ds_read_b128 v[92:95], v10 offset:480
    ds_read_b128 v[96:99], v10 offset:464
    ds_read_b128 v[100:103], v10 offset:992
    ds_read_b128 v[104:107], v10 offset:976
    ds_read_b128 v[240:243], v10 offset:1504
    ds_read_b128 v[244:247], v10 offset:1488
    ds_write_b64 v62, v[74:75]
    ds_write_b64 v64, v[74:75] offset:2768
    s_cmp_ge_u32 s31, 2
    s_cbranch_scc1 Lnoul
    s_add_u32 s5, s31, 6
    s_lshl_b32 s5, s5, 17
    s_add_u32 s38, s8, s5
    s_addc_u32 s39, s9, 0
    global_load_dwordx4 v[192:195], v15, s[38:39]
    global_load_dwordx4 v[196:199], v1, s[38:39]
Lnoul:
    s_waitcnt lgkmcnt(7)
    v_mfma_f32_16x16x32_bf16 v[148:151], v[16:19], v[92:95], 0
    ds_read_b128 v[248:251], v10 offset:480
    v_mfma_f32_16x16x32_bf16 v[216:219], v[92:95], v[20:23], 0
    ds_read_b128 v[252:255], v10 offset:416
    v_mfma_f32_16x16x32_bf16 v[220:223], v[92:95], v[24:27], 0
    ds_read_b128 v[152:155], v10 offset:352
    v_mfma_f32_16x16x32_bf16 v[224:227], v[92:95], v[28:31], 0
    ds_read_b128 v[156:159], v10 offset:288
    s_waitcnt lgkmcnt(10)
    v_mfma_f32_16x16x32_bf16 v[228:231], v[96:99], v[32:35], 0
    ds_read_b128 v[188:191], v10 offset:224
    v_mfma_f32_16x16x32_bf16 v[232:235], v[92:95], v[36:39], 0
    ds_read_b128 v[16:19], v10 offset:160
    v_cvt_pk_bf16_f32 v122, v216, v220
    v_cvt_pk_bf16_f32 v120, v217, v221
    v_mfma_f32_16x16x32_bf16 v[236:239], v[96:99], v[40:43], 0
    ds_read_b128 v[36:39], v10 offset:96
    v_cvt_pk_bf16_f32 v126, v218, v222
    v_cvt_pk_bf16_f32 v124, v219, v223
    s_waitcnt lgkmcnt(12)
    v_mfma_f32_16x16x32_bf16 v[216:219], v[100:103], v[20:23], 0
    ds_read_b128 v[40:43], v10 offset:32
    v_cvt_pk_bf16_f32 v123, v224, v228
    v_cvt_pk_bf16_f32 v121, v225, v229
    v_mfma_f32_16x16x32_bf16 v[220:223], v[100:103], v[24:27], 0
    v_cvt_pk_bf16_f32 v127, v226, v230
    v_cvt_pk_bf16_f32 v125, v227, v231
    v_mfma_f32_16x16x32_bf16 v[224:227], v[100:103], v[28:31], 0
    v_cvt_pk_bf16_f32 v144, v232, v236
    v_cvt_pk_bf16_f32 v145, v233, v237
    s_waitcnt lgkmcnt(12)
    v_mfma_f32_16x16x32_bf16 v[228:231], v[104:107], v[32:35], 0
    v_cvt_pk_bf16_f32 v146, v234, v238
    v_cvt_pk_bf16_f32 v147, v235, v239
    s_waitcnt lgkmcnt(11)
    v_mfma_f32_16x16x32_bf16 v[232:235], v[240:243], v[20:23], 0
    ds_read_b128 v[20:23], v10 offset:992
    v_cvt_pk_bf16_f32 v130, v216, v220
    v_cvt_pk_bf16_f32 v128, v217, v221
    v_mfma_f32_16x16x32_bf16 v[236:239], v[240:243], v[24:27], 0
    ds_read_b128 v[24:27], v10 offset:928
    v_cvt_pk_bf16_f32 v134, v218, v222
    v_cvt_pk_bf16_f32 v132, v219, v223
    v_mfma_f32_16x16x32_bf16 v[216:219], v[240:243], v[28:31], 0
    ds_read_b128 v[240:243], v10 offset:864
    v_cvt_pk_bf16_f32 v131, v224, v228
    v_cvt_pk_bf16_f32 v129, v225, v229
    s_waitcnt lgkmcnt(13)
    v_mfma_f32_16x16x32_bf16 v[220:223], v[244:247], v[32:35], 0
    ds_read_b128 v[28:31], v10 offset:800
    v_cvt_pk_bf16_f32 v135, v226, v230
    v_cvt_pk_bf16_f32 v133, v227, v231
    ds_read_b128 v[244:247], v10 offset:736
    ds_read_b128 v[32:35], v10 offset:672
    v_cvt_pk_bf16_f32 v138, v232, v236
    v_cvt_pk_bf16_f32 v136, v233, v237
    v_cvt_pk_bf16_f32 v142, v234, v238
    v_cvt_pk_bf16_f32 v140, v235, v239
    v_cvt_pk_bf16_f32 v139, v216, v220
    v_cvt_pk_bf16_f32 v137, v217, v221
    v_cvt_pk_bf16_f32 v143, v218, v222
    v_cvt_pk_bf16_f32 v141, v219, v223
    global_load_dwordx4 v[44:47], v14, s[48:49] offset:0 sc1
    global_load_dwordx4 v[48:51], v3, s[48:49] offset:1024 sc1
    s_cmp_ge_u32 s31, 2
    s_cbranch_scc1 Lnosl
    s_waitcnt vmcnt(2)
    v_add_u32 v0, s98, v65
    s_mov_b64 exec, s[46:47]
    global_load_dword v0, v0, s[8:9]
    s_mov_b64 exec, -1
    s_add_u32 s5, s31, 6
    s_lshl_b32 s5, s5, 8
    s_add_u32 m0, s5, 512
    v_perm_b32 v216, v196, v192, s40
    v_perm_b32 v217, v196, v192, s41
    v_perm_b32 v218, v197, v193, s40
    v_perm_b32 v219, v197, v193, s41
    ds_write_addtid_b32 v216 offset:0
    ds_write_addtid_b32 v217 offset:4608
    ds_write_addtid_b32 v218 offset:9216
    ds_write_addtid_b32 v219 offset:13824
    v_perm_b32 v216, v198, v194, s40
    v_perm_b32 v217, v198, v194, s41
    v_perm_b32 v218, v199, v195, s40
    v_perm_b32 v219, v199, v195, s41
    ds_write_addtid_b32 v216 offset:18432
    ds_write_addtid_b32 v217 offset:23040
    ds_write_addtid_b32 v218 offset:27648
    ds_write_addtid_b32 v219 offset:32256
    s_waitcnt lgkmcnt(0)
Lnosl:
    s_waitcnt vmcnt(1)
    s_cmp_ge_u32 s31, 2
    s_cbranch_scc0 LchkA
    s_waitcnt vmcnt(0)
LchkA:
    v_add3_u32 v218, v44, v45, v46
    v_lshl_add_u32 v216, v47, 1, v218
    v_lshl_add_u32 v217, v47, 1, v218
    v_add3_u32 v218, v48, v49, v50
    v_sub_u32 v218, v51, v218
    v_permlane32_swap_b32 v216, v217
    v_add3_u32 v216, v216, v217, s50
    v_cmp_ne_u32 vcc, v216, v218
    s_mov_b32 exec_lo, 0
    v_mov_b32 v48, v50
    v_perm_b32 v49, v44, v44, s40
    s_mov_b32 exec_lo, -1
    s_cmp_eq_u64 vcc, 0
    s_cbranch_scc1 LgotA
    global_load_dwordx4 v[44:47], v14, s[48:49] offset:0 sc1
    global_load_dwordx4 v[48:51], v3, s[48:49] offset:1024 sc1
    s_add_u32 s51, s51, 1
    s_cmp_ge_u32 s51, 0x40000
    s_waitcnt vmcnt(0)
    s_cbranch_scc0 LchkA
LgotA:
    s_mov_b32 m0, s29
    v_mov_b32_dpp v160, v45 wave_shr:1 row_mask:0xf bank_mask:0xf bound_ctrl:0
    v_mov_b32_dpp v164, v45 row_newbcast:15 row_mask:0xf bank_mask:0xf
    v_readlane_b32 s36, v46, 63
    v_alignbit_b32 v161, v48, v44, 16
    v_alignbit_b32 v162, v44, v49, 16
    v_alignbit_b32 v163, v49, v45, 16
    v_alignbit_b32 v160, v160, v48, 16
    ds_write_addtid_b32 v46 offset:2888
    ds_write_addtid_b32 v46 offset:3264
    ds_write_b16 v7, v47 offset:3648
    ds_write_b16_d16_hi v7, v47 offset:3776
    ds_write_addtid_b32 v160 offset:552
    ds_write_addtid_b32 v48 offset:824
    ds_write_addtid_b32 v161 offset:1096
    ds_write_addtid_b32 v44 offset:1368
    ds_write_addtid_b32 v162 offset:1640
    ds_write_addtid_b32 v49 offset:1912
    ds_write_addtid_b32 v163 offset:2184
    ds_write_addtid_b32 v45 offset:2456
    ds_write_addtid_b32 v163 offset:12
    ds_write_addtid_b32 v45 offset:284
    s_mov_b32 exec_lo, 0
    s_mov_b32 exec_hi, 0xbf0000
    ds_write_b16 v9, v164 offset:808
    s_mov_b64 exec, -1
    ds_read2_b32 v[52:53], v4 offset0:136 offset1:0
    ds_read2_b32 v[54:55], v5 offset0:136 offset1:0
    ds_read2_b32 v[56:57], v4 offset0:140 offset1:4
    ds_read2_b32 v[58:59], v5 offset0:140 offset1:4
    ds_read2_b32 v[60:61], v4 offset0:144 offset1:8
    ds_read2_b32 v[62:63], v5 offset0:144 offset1:8
    ds_read2_b32 v[64:65], v4 offset0:148 offset1:12
    ds_read2_b32 v[66:67], v5 offset0:148 offset1:12
    ds_read2_b32 v[68:69], v4 offset0:152 offset1:16
    ds_read2_b32 v[70:71], v5 offset0:152 offset1:16
    ds_read2_b32 v[72:73], v4 offset0:156 offset1:20
    ds_read2_b32 v[74:75], v5 offset0:156 offset1:20
    ds_read2_b32 v[76:77], v4 offset0:160 offset1:24
    ds_read2_b32 v[78:79], v5 offset0:160 offset1:24
    ds_read2_b32 v[80:81], v4 offset0:164 offset1:28
    ds_read2_b32 v[82:83], v5 offset0:164 offset1:28
    s_cmp_ge_u32 s31, 2
    s_cbranch_scc0 Lnoum
    s_add_u32 s5, s31, 6
    s_lshl_b32 s5, s5, 17
    s_add_u32 s38, s8, s5
    s_addc_u32 s39, s9, 0
    global_load_dwordx4 v[192:195], v15, s[38:39]
    global_load_dwordx4 v[196:199], v1, s[38:39]
Lnoum:
    s_and_b32 s36, s36, 0xffff0000
    s_waitcnt lgkmcnt(14)
    v_mfma_f32_16x16x32_bf16 v[200:203], v[52:55], v[248:251], 0
    ds_read2_b32 v[116:117], v4 offset0:200 offset1:64
    ds_read2_b32 v[118:119], v5 offset0:200 offset1:64
    v_mul_f32 v148, s36, v148
    s_waitcnt lgkmcnt(14)
    v_mfma_f32_16x16x32_bf16 v[200:203], v[56:59], v[252:255], v[200:203]
    ds_read2_b32 v[84:85], v4 offset0:168 offset1:32
    ds_read2_b32 v[86:87], v5 offset0:168 offset1:32
    v_mul_f32 v149, s36, v149
    s_waitcnt lgkmcnt(14)
    v_mfma_f32_16x16x32_bf16 v[200:203], v[60:63], v[152:155], v[200:203]
    ds_read2_b32 v[88:89], v4 offset0:172 offset1:36
    ds_read2_b32 v[90:91], v5 offset0:172 offset1:36
    v_mul_f32 v150, s36, v150
    s_waitcnt lgkmcnt(14)
    v_mfma_f32_16x16x32_bf16 v[200:203], v[64:67], v[156:159], v[200:203]
    ds_read2_b32 v[92:93], v4 offset0:176 offset1:40
    ds_read2_b32 v[94:95], v5 offset0:176 offset1:40
    v_mul_f32 v151, s36, v151
    s_waitcnt lgkmcnt(14)
    v_mfma_f32_16x16x32_bf16 v[200:203], v[68:71], v[188:191], v[200:203]
    ds_read2_b32 v[96:97], v4 offset0:180 offset1:44
    ds_read2_b32 v[98:99], v5 offset0:180 offset1:44
    s_waitcnt lgkmcnt(14)
    v_mfma_f32_16x16x32_bf16 v[200:203], v[72:75], v[16:19], v[200:203]
    ds_read2_b32 v[100:101], v4 offset0:184 offset1:48
    ds_read2_b32 v[102:103], v5 offset0:184 offset1:48
    s_waitcnt lgkmcnt(14)
    v_mfma_f32_16x16x32_bf16 v[200:203], v[76:79], v[36:39], v[200:203]
    ds_read2_b32 v[104:105], v4 offset0:188 offset1:52
    ds_read2_b32 v[106:107], v5 offset0:188 offset1:52
    s_waitcnt lgkmcnt(14)
    v_mfma_f32_16x16x32_bf16 v[200:203], v[80:83], v[40:43], v[200:203]
    ds_read2_b32 v[108:109], v4 offset0:192 offset1:56
    ds_read2_b32 v[110:111], v5 offset0:192 offset1:56
    s_waitcnt lgkmcnt(14)
    v_mfma_f32_16x16x32_bf16 v[208:211], v[116:119], v[248:251], 0
    ds_read2_b32 v[112:113], v4 offset0:196 offset1:60
    ds_read2_b32 v[114:115], v5 offset0:196 offset1:60
    s_waitcnt lgkmcnt(14)
    v_mfma_f32_16x16x32_bf16 v[204:207], v[84:87], v[248:251], 0
    ds_read_b128 v[248:251], v10 offset:608
    v_cvt_pk_bf16_f32 v44, v200, v201
    v_cvt_pk_bf16_f32 v45, v202, v203
    s_waitcnt lgkmcnt(13)
    v_mfma_f32_16x16x32_bf16 v[204:207], v[88:91], v[252:255], v[204:207]
    ds_write_b64 v11, v[44:45] offset:4352
    s_waitcnt lgkmcnt(12)
    v_mfma_f32_16x16x32_bf16 v[204:207], v[92:95], v[152:155], v[204:207]
    s_waitcnt lgkmcnt(0)
    s_barrier
    v_mfma_f32_16x16x32_bf16 v[204:207], v[96:99], v[156:159], v[204:207]
    ds_read_b128 v[252:255], v10 offset:544
    v_mfma_f32_16x16x32_bf16 v[204:207], v[100:103], v[188:191], v[204:207]
    ds_read_b128 v[160:163], v6 offset:2784
    v_mfma_f32_16x16x32_bf16 v[204:207], v[104:107], v[16:19], v[204:207]
    ds_read_b128 v[164:167], v6 offset:2768
    v_mfma_f32_16x16x32_bf16 v[204:207], v[108:111], v[36:39], v[204:207]
    ds_read_b128 v[152:155], v10 offset:1504
    v_mfma_f32_16x16x32_bf16 v[204:207], v[112:115], v[40:43], v[204:207]
    ds_read_b128 v[156:159], v10 offset:1440
    v_mfma_f32_16x16x32_bf16 v[204:207], v[52:55], v[20:23], v[204:207]
    ds_read_b128 v[188:191], v10 offset:1376
    v_mfma_f32_16x16x32_bf16 v[204:207], v[56:59], v[24:27], v[204:207]
    ds_read_b128 v[16:19], v10 offset:1312
    v_mfma_f32_16x16x32_bf16 v[204:207], v[60:63], v[240:243], v[204:207]
    ds_read_b128 v[36:39], v10 offset:1248
    v_mfma_f32_16x16x32_bf16 v[204:207], v[64:67], v[28:31], v[204:207]
    ds_read_b128 v[40:43], v10 offset:1184
    v_mfma_f32_16x16x32_bf16 v[204:207], v[68:71], v[244:247], v[204:207]
    ds_read_b128 v[168:171], v6 offset:2912
    v_mfma_f32_16x16x32_bf16 v[204:207], v[72:75], v[32:35], v[204:207]
    ds_read_b128 v[172:175], v6 offset:2896
    v_mfma_f32_16x16x32_bf16 v[204:207], v[76:79], v[248:251], v[204:207]
    ds_read_b128 v[176:179], v6 offset:3040
    s_waitcnt lgkmcnt(11)
    v_mfma_f32_16x16x32_bf16 v[204:207], v[80:83], v[252:255], v[204:207]
    ds_read_b128 v[180:183], v6 offset:3024
    s_cmp_eq_u32 s4, 4
    s_cbranch_scc0 Lnoe
    v_mov_b32 v1, s44
    v_mov_b32 v15, s50
    global_store_dword v1, v15, s[48:49] sc1
Lnoe:
    v_mfma_f32_16x16x32_bf16 v[212:215], v[116:119], v[20:23], 0
    ds_read2_b32 v[184:185], v8 offset0:3 offset1:2
    v_mfma_f32_16x16x32_bf16 v[208:211], v[84:87], v[20:23], v[208:211]
    ds_read_b128 v[20:23], v10 offset:1120
    v_mfma_f32_16x16x32_bf16 v[208:211], v[88:91], v[24:27], v[208:211]
    ds_read_b128 v[24:27], v10 offset:1056
    v_mfma_f32_16x16x32_bf16 v[208:211], v[92:95], v[240:243], v[208:211]
    ds_read_b128 v[240:243], v10 offset:2016
    v_cvt_pk_bf16_f32 v44, v204, v205
    v_cvt_pk_bf16_f32 v45, v206, v207
    v_mfma_f32_16x16x32_bf16 v[208:211], v[96:99], v[28:31], v[208:211]
    ds_write_b64 v11, v[44:45] offset:4928
    v_mfma_f32_16x16x32_bf16 v[208:211], v[100:103], v[244:247], v[208:211]
    ds_read_b128 v[28:31], v10 offset:1952
    v_mfma_f32_16x16x32_bf16 v[208:211], v[104:107], v[32:35], v[208:211]
    ds_read_b128 v[244:247], v10 offset:1888
    v_mfma_f32_16x16x32_bf16 v[208:211], v[108:111], v[248:251], v[208:211]
    s_waitcnt lgkmcnt(2)
    s_barrier
    v_mfma_f32_16x16x32_bf16 v[208:211], v[112:115], v[252:255], v[208:211]
    ds_read_b128 v[32:35], v10 offset:1824
    v_mfma_f32_16x16x32_bf16 v[208:211], v[120:123], v[160:163], v[208:211]
    ds_read_b128 v[248:251], v10 offset:1760
    v_mfma_f32_16x16x32_bf16 v[208:211], v[124:127], v[164:167], v[208:211]
    ds_read_b128 v[252:255], v10 offset:1696
    v_mfma_f32_16x16x32_bf16 v[208:211], v[52:55], v[152:155], v[208:211]
    ds_read2_b32 v[186:187], v8 offset0:1 offset1:0
    v_mfma_f32_16x16x32_bf16 v[208:211], v[56:59], v[156:159], v[208:211]
    v_mfma_f32_16x16x32_bf16 v[208:211], v[60:63], v[188:191], v[208:211]
    v_mfma_f32_16x16x32_bf16 v[208:211], v[64:67], v[16:19], v[208:211]
    v_mfma_f32_16x16x32_bf16 v[208:211], v[68:71], v[36:39], v[208:211]
    v_mfma_f32_16x16x32_bf16 v[208:211], v[72:75], v[40:43], v[208:211]
    v_mfma_f32_16x16x32_bf16 v[208:211], v[76:79], v[20:23], v[208:211]
    v_mfma_f32_16x16x32_bf16 v[208:211], v[80:83], v[24:27], v[208:211]
    s_cmp_ge_u32 s31, 2
    s_cbranch_scc0 Lnosm
    s_waitcnt vmcnt(0)
    s_add_u32 s5, s31, 6
    s_lshl_b32 s5, s5, 8
    s_add_u32 m0, s5, 512
    v_perm_b32 v216, v196, v192, s40
    v_perm_b32 v217, v196, v192, s41
    v_perm_b32 v218, v197, v193, s40
    v_perm_b32 v219, v197, v193, s41
    ds_write_addtid_b32 v216 offset:0
    ds_write_addtid_b32 v217 offset:4608
    ds_write_addtid_b32 v218 offset:9216
    ds_write_addtid_b32 v219 offset:13824
    v_perm_b32 v216, v198, v194, s40
    v_perm_b32 v217, v198, v194, s41
    v_perm_b32 v218, v199, v195, s40
    v_perm_b32 v219, v199, v195, s41
    ds_write_addtid_b32 v216 offset:18432
    ds_write_addtid_b32 v217 offset:23040
    ds_write_addtid_b32 v218 offset:27648
    ds_write_addtid_b32 v219 offset:32256
    s_waitcnt lgkmcnt(0)
Lnosm:
    v_mfma_f32_16x16x32_bf16 v[148:151], v[116:119], v[152:155], v[148:151]
    v_mfma_f32_16x16x32_bf16 v[212:215], v[84:87], v[152:155], v[212:215]
    ds_read_b128 v[152:155], v10 offset:1632
    v_mfma_f32_16x16x32_bf16 v[212:215], v[88:91], v[156:159], v[212:215]
    ds_read_b128 v[156:159], v10 offset:1568
    v_mfma_f32_16x16x32_bf16 v[212:215], v[92:95], v[188:191], v[212:215]
    v_cvt_pk_bf16_f32 v44, v208, v209
    v_cvt_pk_bf16_f32 v45, v210, v211
    v_mfma_f32_16x16x32_bf16 v[212:215], v[96:99], v[16:19], v[212:215]
    ds_write_b64 v11, v[44:45] offset:5504
    v_mfma_f32_16x16x32_bf16 v[212:215], v[100:103], v[36:39], v[212:215]
    v_mfma_f32_16x16x32_bf16 v[212:215], v[104:107], v[40:43], v[212:215]
    v_mfma_f32_16x16x32_bf16 v[212:215], v[108:111], v[20:23], v[212:215]
    s_waitcnt lgkmcnt(0)
    s_barrier
    v_mfma_f32_16x16x32_bf16 v[212:215], v[112:115], v[24:27], v[212:215]
    ds_read_b128 v[188:191], v10 offset:2528
    v_mfma_f32_16x16x32_bf16 v[212:215], v[128:131], v[160:163], v[212:215]
    ds_read_b128 v[16:19], v10 offset:2464
    v_mfma_f32_16x16x32_bf16 v[212:215], v[132:135], v[164:167], v[212:215]
    ds_read_b128 v[36:39], v10 offset:2400
    v_mfma_f32_16x16x32_bf16 v[212:215], v[120:123], v[168:171], v[212:215]
    ds_read_b128 v[40:43], v10 offset:2336
    v_mfma_f32_16x16x32_bf16 v[212:215], v[124:127], v[172:175], v[212:215]
    ds_read_b128 v[20:23], v10 offset:2272
    v_mfma_f32_16x16x32_bf16 v[212:215], v[52:55], v[240:243], v[212:215]
    ds_read_b128 v[24:27], v10 offset:2208
    v_mfma_f32_16x16x32_bf16 v[212:215], v[56:59], v[28:31], v[212:215]
    v_mfma_f32_16x16x32_bf16 v[212:215], v[60:63], v[244:247], v[212:215]
    v_mfma_f32_16x16x32_bf16 v[212:215], v[64:67], v[32:35], v[212:215]
    v_mfma_f32_16x16x32_bf16 v[212:215], v[68:71], v[248:251], v[212:215]
    v_mfma_f32_16x16x32_bf16 v[212:215], v[72:75], v[252:255], v[212:215]
    v_mfma_f32_16x16x32_bf16 v[212:215], v[76:79], v[152:155], v[212:215]
    v_mfma_f32_16x16x32_bf16 v[212:215], v[80:83], v[156:159], v[212:215]
    v_mfma_f32_16x16x32_bf16 v[148:151], v[84:87], v[240:243], v[148:151]
    ds_read_b128 v[240:243], v10 offset:2144
    v_mfma_f32_16x16x32_bf16 v[148:151], v[88:91], v[28:31], v[148:151]
    ds_read_b128 v[28:31], v10 offset:2080
    v_mfma_f32_16x16x32_bf16 v[148:151], v[92:95], v[244:247], v[148:151]
    v_mfma_f32_16x16x32_bf16 v[148:151], v[96:99], v[32:35], v[148:151]
    s_nop 1
    v_cvt_pk_bf16_f32 v44, v212, v213
    v_cvt_pk_bf16_f32 v45, v214, v215
    v_mfma_f32_16x16x32_bf16 v[148:151], v[100:103], v[248:251], v[148:151]
    ds_write_b64 v11, v[44:45] offset:6080
    v_mfma_f32_16x16x32_bf16 v[148:151], v[104:107], v[252:255], v[148:151]
    v_mfma_f32_16x16x32_bf16 v[148:151], v[108:111], v[152:155], v[148:151]
    v_mfma_f32_16x16x32_bf16 v[148:151], v[112:115], v[156:159], v[148:151]
    s_waitcnt lgkmcnt(0)
    s_barrier
    v_mfma_f32_16x16x32_bf16 v[148:151], v[136:139], v[160:163], v[148:151]
    v_mfma_f32_16x16x32_bf16 v[148:151], v[140:143], v[164:167], v[148:151]
    v_mfma_f32_16x16x32_bf16 v[148:151], v[128:131], v[168:171], v[148:151]
    v_mfma_f32_16x16x32_bf16 v[148:151], v[132:135], v[172:175], v[148:151]
    v_mfma_f32_16x16x32_bf16 v[148:151], v[120:123], v[176:179], v[148:151]
    v_mfma_f32_16x16x32_bf16 v[148:151], v[124:127], v[180:183], v[148:151]
    v_mfma_f32_16x16x32_bf16 v[148:151], v[144:147], v[184:187], v[148:151]
    v_mfma_f32_16x16x32_bf16 v[148:151], v[52:55], v[188:191], v[148:151]
    v_mfma_f32_16x16x32_bf16 v[148:151], v[56:59], v[16:19], v[148:151]
    v_mfma_f32_16x16x32_bf16 v[148:151], v[60:63], v[36:39], v[148:151]
    v_mfma_f32_16x16x32_bf16 v[148:151], v[64:67], v[40:43], v[148:151]
    v_mfma_f32_16x16x32_bf16 v[148:151], v[68:71], v[20:23], v[148:151]
    v_mfma_f32_16x16x32_bf16 v[148:151], v[72:75], v[24:27], v[148:151]
    v_mfma_f32_16x16x32_bf16 v[148:151], v[76:79], v[240:243], v[148:151]
    v_mfma_f32_16x16x32_bf16 v[148:151], v[80:83], v[28:31], v[148:151]
    s_nop 7
    v_cvt_pk_bf16_f32 v44, v148, v149
    v_cvt_pk_bf16_f32 v45, v150, v151
    ds_write_b64 v11, v[44:45] offset:6656
    s_waitcnt lgkmcnt(0)
    s_barrier
    s_endpgm
Lend:
    s_endpgm
.section .rodata,"a"
.p2align 6
.amdhsa_kernel concat_heads__ssm_conv_s4d__ssm_conv_s4__prompt_kernel
  .amdhsa_next_free_vgpr 256
  .amdhsa_next_free_sgpr 102
  .amdhsa_accum_offset 256
  .amdhsa_group_segment_fixed_size 0
  .amdhsa_kernarg_size 152
  .amdhsa_user_sgpr_count 2
  .amdhsa_user_sgpr_kernarg_segment_ptr 1
  .amdhsa_system_sgpr_workgroup_id_x 1
.end_amdhsa_kernel
```
